```python
import torch

def _softmax(x, axis=-1):
    return torch.softmax(x, dim=axis)
def _gelu(x):
    return torch.nn.functional.gelu(x, approximate="tanh")
def _silu(x):
    return torch.nn.functional.silu(x)
def _sigmoid(x):
    return torch.sigmoid(x)
def _layernorm(x, axis=-1, eps=1e-5):
    m = x.mean(dim=axis, keepdim=True)
    v = x.var(dim=axis, keepdim=True, unbiased=False)
    return (x - m) / torch.sqrt(v + eps)
def _scatter_add(tgt, idx, src, axis=0):
    return tgt.clone().index_add_(axis, idx, src)
def _segment_sum(src, seg, n):
    out = torch.zeros((n,) + src.shape[1:], dtype=src.dtype)
    return out.index_add_(0, seg, src)
def _pad(x, pw):
    flat = tuple(v for pair in reversed(pw) for v in pair)
    return torch.nn.functional.pad(x, flat)

kernel_name = 'standalone__ragged_sequences_packed_sequences__ragged'

def setup_inputs():

    _w = (lambda a: (lambda t: t.to(torch.bfloat16) if t.is_floating_point() else t)(torch.as_tensor(a)))
    cu = torch.tensor([0, 370, 478, 621, 984, 1149, 1581, 1681, 2146], dtype=torch.int64)
    T = int(cu[-1])
    H, D = 16, 128
    lens = torch.diff(cu)
    seg_ids = torch.repeat_interleave(torch.arange(len(lens), dtype=torch.int64), lens)
    return {
        "q": _w((lambda *s: torch.randn(*s, dtype=torch.bfloat16) * 0.8)(T, H, D)),
        "k": _w((lambda *s: torch.randn(*s, dtype=torch.bfloat16) * 0.8)(T, H, D)),
        "v": _w((lambda *s: torch.randn(*s, dtype=torch.bfloat16) * 0.05)(T, H, D)),
        "seg_ids": _w(seg_ids),
    }

def reference(q, k, v, seg_ids):
    T, H, D = q.shape
    scale = D ** -0.5
    same_seq = seg_ids[:, None] == seg_ids[None, :]
    logits = torch.einsum("qhd,khd->hqk", q, k) * scale
    bias = (1.0 - (lambda x, dt: x.to(dt))(same_seq, q.dtype)) * (-1e9)
    p = _softmax(logits + bias[None, :, :], axis=-1)
    return torch.einsum("hqk,khd->qhd", p, v)
```

```asm
; @launch grid=(256,1,1) block=(512,1,1) lds=152576
.amdgcn_target "amdgcn-amd-amdhsa--gfx950"
.text
.globl standalone__ragged_sequences_packed_sequences__ragged_kernel
.p2align 8
.type standalone__ragged_sequences_packed_sequences__ragged_kernel,@function
standalone__ragged_sequences_packed_sequences__ragged_kernel:
    s_load_dwordx8 s[4:11], s[0:1], 0
    s_lshr_b32 s3, s2, 8
    s_cbranch_scc1 L_end
    s_getpc_b64 s[14:15]
L_pc:
    s_lshl_b32 s3, s2, 5
    s_add_u32 s3, s3, L_table-L_pc
    s_load_dwordx8 s[84:91], s[14:15], s3
    s_and_b32 s48, s2, -8
    s_lshl_b32 s48, s48, 7
    v_lshl_add_u32 v22, v0, 1, s48
    global_load_ushort v21, v22, s[14:15]
    s_load_dwordx2 s[12:13], s[0:1], 32
    v_lshrrev_b32 v1, 6, v0
    v_and_b32 v0, 63, v0
    v_readfirstlane_b32 s18, v1
    v_lshrrev_b32 v2, 4, v0
    v_and_b32 v3, 1, v2
    v_and_b32 v4, 15, v0
    v_xor_b32 v4, v4, v3
    v_lshlrev_b32 v4, 4, v4
    v_and_b32 v1, 3, v1
    v_lshl_add_u32 v2, v1, 3, v2
    v_lshl_add_u32 v28, v2, 12, v4
    v_add_u32 v29, 16384, v28
    s_mov_b32 s23, 0x20000
    s_cmp_lt_u32 s18, 4
    s_waitcnt lgkmcnt(0)
    s_cselect_b32 s48, s85, s84
    s_add_u32 s20, s4, s88
    s_addc_u32 s21, s5, 0
    s_mov_b32 s22, s87
    s_add_u32 s49, s48, 131072
    buffer_load_dwordx4 v[112:115], v28, s[20:23], s48 offen nt
    buffer_load_dwordx4 v[116:119], v29, s[20:23], s48 offen nt
    buffer_load_dwordx4 v[120:123], v28, s[20:23], s49 offen nt
    buffer_load_dwordx4 v[124:127], v29, s[20:23], s49 offen nt
    s_cmp_lt_u32 s18, 4
    s_cbranch_scc1 L_cons
    s_setprio 3
    s_add_u32 s24, s6, s88
    s_addc_u32 s25, s7, 0
    s_mov_b32 s26, s87
    s_mov_b32 s27, 0x20000
    s_sub_u32 s48, s18, 4
    s_mul_i32 s50, s48, 2112
    v_add_u32 v2, 15328, v28
    s_bfe_u32 s71, s89, 0x2000b
    s_lshl_b32 s46, s71, 17
    s_xor_b32 s47, s46, 131072
    s_add_u32 s46, s46, s86
    s_add_u32 s47, s47, s86
    s_bitcmp1_b32 s89, 8
    s_cbranch_scc1 L_pdual
    s_bitcmp1_b32 s89, 9
    s_cbranch_scc1 L_pkeep
    s_bitcmp1_b32 s89, 15
    s_cbranch_scc1 L_pgen
    s_add_u32 s44, s50, 16896
    s_add_u32 s45, s50, 135168
    s_mov_b32 m0, s44
    s_add_u32 s48, s44, 8448
    buffer_load_dwordx4 v28, s[24:27], s46 offen nt lds
    buffer_load_dwordx4 v2, s[24:27], s46 offen offset:1056 nt lds
    s_mov_b32 m0, s48
    s_add_u32 s44, s44, 16896
    buffer_load_dwordx4 v28, s[24:27], s47 offen nt lds
    buffer_load_dwordx4 v2, s[24:27], s47 offen offset:1056 nt lds
    s_cmp_eq_u32 s44, s45
    s_cselect_b32 s44, s50, s44
    s_mov_b32 s68, s44
    s_add_u32 s44, s44, 33792
    s_mov_b32 s19, s88
    s_add_u32 s28, s8, s19
    s_addc_u32 s29, s9, 0
    s_mov_b32 s31, 0x20000
    s_mov_b32 s30, s87
    s_add_u32 s47, s46, 262144
    s_and_b32 s42, s89, 255
    s_mov_b32 s37, s91
    s_mov_b32 s73, s86
    s_mov_b32 s70, 0
    s_sub_u32 s72, s42, 1
    s_bitcmp1_b32 s89, 13
    s_cselect_b32 s48, -4, -2
    s_and_b32 s72, s72, s48
    v_lshlrev_b32 v40, 4, v0
    s_mov_b32 s59, 0x3e0293ee
    v_mov_b32 v52, s59
    v_mov_b32 v53, s59
    v_add_u32 v41, s68, v40
    s_waitcnt vmcnt(7)
    v_lshlrev_b32 v44, 16, v112
    v_and_b32 v45, 0xffff0000, v112
    v_pk_mul_f32 v[44:45], v[44:45], v[52:53]
    v_cvt_pk_bf16_f32 v112, v44, v45
    v_lshlrev_b32 v46, 16, v113
    v_and_b32 v47, 0xffff0000, v113
    v_pk_mul_f32 v[46:47], v[46:47], v[52:53]
    v_cvt_pk_bf16_f32 v113, v46, v47
    v_lshlrev_b32 v48, 16, v114
    v_and_b32 v49, 0xffff0000, v114
    v_pk_mul_f32 v[48:49], v[48:49], v[52:53]
    v_cvt_pk_bf16_f32 v114, v48, v49
    v_lshlrev_b32 v50, 16, v115
    v_and_b32 v51, 0xffff0000, v115
    v_pk_mul_f32 v[50:51], v[50:51], v[52:53]
    v_cvt_pk_bf16_f32 v115, v50, v51
    ds_write_b128 v41, v[112:115] offset:0
    s_waitcnt vmcnt(6)
    v_lshlrev_b32 v44, 16, v116
    v_and_b32 v45, 0xffff0000, v116
    v_pk_mul_f32 v[44:45], v[44:45], v[52:53]
    v_cvt_pk_bf16_f32 v116, v44, v45
    v_lshlrev_b32 v46, 16, v117
    v_and_b32 v47, 0xffff0000, v117
    v_pk_mul_f32 v[46:47], v[46:47], v[52:53]
    v_cvt_pk_bf16_f32 v117, v46, v47
    v_lshlrev_b32 v48, 16, v118
    v_and_b32 v49, 0xffff0000, v118
    v_pk_mul_f32 v[48:49], v[48:49], v[52:53]
    v_cvt_pk_bf16_f32 v118, v48, v49
    v_lshlrev_b32 v50, 16, v119
    v_and_b32 v51, 0xffff0000, v119
    v_pk_mul_f32 v[50:51], v[50:51], v[52:53]
    v_cvt_pk_bf16_f32 v119, v50, v51
    ds_write_b128 v41, v[116:119] offset:1056
    s_add_u32 s46, s70, 0
    s_cmp_lt_u32 s46, s72
    s_cselect_b32 s48, s71, 0
    s_xor_b32 s46, s46, s48
    s_lshl_b32 s46, s46, 17
    s_add_u32 s46, s46, s73
    s_add_u32 s47, s70, 2
    s_cmp_lt_u32 s47, s72
    s_cselect_b32 s48, s71, 0
    s_xor_b32 s47, s47, s48
    s_lshl_b32 s47, s47, 17
    s_add_u32 s47, s47, s73
    s_add_u32 s70, s70, 1
    s_mov_b32 m0, s44
    s_add_u32 s48, s44, 8448
    buffer_load_dwordx4 v28, s[28:31], s46 offen nt lds
    buffer_load_dwordx4 v2, s[28:31], s46 offen offset:1056 nt lds
    s_mov_b32 m0, s48
    s_add_u32 s44, s44, 16896
    buffer_load_dwordx4 v28, s[24:27], s47 offen nt lds
    buffer_load_dwordx4 v2, s[24:27], s47 offen offset:1056 nt lds
    s_cmp_eq_u32 s44, s45
    s_cselect_b32 s44, s50, s44
    s_waitcnt vmcnt(9)
    v_lshlrev_b32 v44, 16, v120
    v_and_b32 v45, 0xffff0000, v120
    v_pk_mul_f32 v[44:45], v[44:45], v[52:53]
    v_cvt_pk_bf16_f32 v120, v44, v45
    v_lshlrev_b32 v46, 16, v121
    v_and_b32 v47, 0xffff0000, v121
    v_pk_mul_f32 v[46:47], v[46:47], v[52:53]
    v_cvt_pk_bf16_f32 v121, v46, v47
    v_lshlrev_b32 v48, 16, v122
    v_and_b32 v49, 0xffff0000, v122
    v_pk_mul_f32 v[48:49], v[48:49], v[52:53]
    v_cvt_pk_bf16_f32 v122, v48, v49
    v_lshlrev_b32 v50, 16, v123
    v_and_b32 v51, 0xffff0000, v123
    v_pk_mul_f32 v[50:51], v[50:51], v[52:53]
    v_cvt_pk_bf16_f32 v123, v50, v51
    ds_write_b128 v41, v[120:123] offset:8448
    s_waitcnt vmcnt(8)
    v_lshlrev_b32 v44, 16, v124
    v_and_b32 v45, 0xffff0000, v124
    v_pk_mul_f32 v[44:45], v[44:45], v[52:53]
    v_cvt_pk_bf16_f32 v124, v44, v45
    v_lshlrev_b32 v46, 16, v125
    v_and_b32 v47, 0xffff0000, v125
    v_pk_mul_f32 v[46:47], v[46:47], v[52:53]
    v_cvt_pk_bf16_f32 v125, v46, v47
    v_lshlrev_b32 v48, 16, v126
    v_and_b32 v49, 0xffff0000, v126
    v_pk_mul_f32 v[48:49], v[48:49], v[52:53]
    v_cvt_pk_bf16_f32 v126, v48, v49
    v_lshlrev_b32 v50, 16, v127
    v_and_b32 v51, 0xffff0000, v127
    v_pk_mul_f32 v[50:51], v[50:51], v[52:53]
    v_cvt_pk_bf16_f32 v127, v50, v51
    ds_write_b128 v41, v[124:127] offset:9504
    s_waitcnt vmcnt(4)
    s_waitcnt lgkmcnt(0)
    s_barrier
    s_add_u32 s46, s70, 0
    s_cmp_lt_u32 s46, s72
    s_cselect_b32 s48, s71, 0
    s_xor_b32 s46, s46, s48
    s_lshl_b32 s46, s46, 17
    s_add_u32 s46, s46, s73
    s_add_u32 s47, s70, 2
    s_cmp_lt_u32 s47, s72
    s_cselect_b32 s48, s71, 0
    s_xor_b32 s47, s47, s48
    s_lshl_b32 s47, s47, 17
    s_add_u32 s47, s47, s73
    s_add_u32 s70, s70, 1
    s_mov_b32 m0, s44
    s_add_u32 s48, s44, 8448
    buffer_load_dwordx4 v28, s[28:31], s46 offen nt lds
    buffer_load_dwordx4 v2, s[28:31], s46 offen offset:1056 nt lds
    s_mov_b32 m0, s48
    s_add_u32 s44, s44, 16896
    buffer_load_dwordx4 v28, s[24:27], s47 offen nt lds
    buffer_load_dwordx4 v2, s[24:27], s47 offen offset:1056 nt lds
    s_cmp_eq_u32 s44, s45
    s_cselect_b32 s44, s50, s44
    s_add_u32 s46, s70, 0
    s_cmp_lt_u32 s46, s72
    s_cselect_b32 s48, s71, 0
    s_xor_b32 s46, s46, s48
    s_lshl_b32 s46, s46, 17
    s_add_u32 s46, s46, s73
    s_add_u32 s47, s70, 2
    s_cmp_lt_u32 s47, s72
    s_cselect_b32 s48, s71, 0
    s_xor_b32 s47, s47, s48
    s_lshl_b32 s47, s47, 17
    s_add_u32 s47, s47, s73
    s_add_u32 s70, s70, 1
    s_mov_b32 m0, s44
    s_add_u32 s48, s44, 8448
    buffer_load_dwordx4 v28, s[28:31], s46 offen nt lds
    buffer_load_dwordx4 v2, s[28:31], s46 offen offset:1056 nt lds
    s_mov_b32 m0, s48
    s_add_u32 s44, s44, 16896
    buffer_load_dwordx4 v28, s[24:27], s47 offen nt lds
    buffer_load_dwordx4 v2, s[24:27], s47 offen offset:1056 nt lds
    s_cmp_eq_u32 s44, s45
    s_cselect_b32 s44, s50, s44
    s_waitcnt vmcnt(8)
    s_barrier
    s_add_u32 s46, s70, 0
    s_cmp_lt_u32 s46, s72
    s_cselect_b32 s48, s71, 0
    s_xor_b32 s46, s46, s48
    s_lshl_b32 s46, s46, 17
    s_add_u32 s46, s46, s73
    s_add_u32 s47, s70, 2
    s_cmp_lt_u32 s47, s72
    s_cselect_b32 s48, s71, 0
    s_xor_b32 s47, s47, s48
    s_lshl_b32 s47, s47, 17
    s_add_u32 s47, s47, s73
    s_add_u32 s70, s70, 1
    s_mov_b32 m0, s44
    s_add_u32 s48, s44, 8448
    buffer_load_dwordx4 v28, s[28:31], s46 offen nt lds
    buffer_load_dwordx4 v2, s[28:31], s46 offen offset:1056 nt lds
    s_mov_b32 m0, s48
    s_add_u32 s44, s44, 16896
    buffer_load_dwordx4 v28, s[24:27], s47 offen nt lds
    buffer_load_dwordx4 v2, s[24:27], s47 offen offset:1056 nt lds
    s_cmp_eq_u32 s44, s45
    s_cselect_b32 s44, s50, s44
    s_add_u32 s46, s70, 0
    s_cmp_lt_u32 s46, s72
    s_cselect_b32 s48, s71, 0
    s_xor_b32 s46, s46, s48
    s_lshl_b32 s46, s46, 17
    s_add_u32 s46, s46, s73
    s_add_u32 s47, s70, 2
    s_cmp_lt_u32 s47, s72
    s_cselect_b32 s48, s71, 0
    s_xor_b32 s47, s47, s48
    s_lshl_b32 s47, s47, 17
    s_add_u32 s47, s47, s73
    s_add_u32 s70, s70, 1
    s_mov_b32 m0, s44
    s_add_u32 s48, s44, 8448
    buffer_load_dwordx4 v28, s[28:31], s46 offen nt lds
    s_waitcnt vmcnt(12)
    buffer_load_dwordx4 v2, s[28:31], s46 offen offset:1056 nt lds
    s_mov_b32 m0, s48
    s_add_u32 s44, s44, 16896
    s_waitcnt vmcnt(12)
    buffer_load_dwordx4 v28, s[24:27], s47 offen nt lds
    s_waitcnt vmcnt(12)
    buffer_load_dwordx4 v2, s[24:27], s47 offen offset:1056 nt lds
    s_cmp_eq_u32 s44, s45
    s_cselect_b32 s44, s50, s44
    s_setprio 0
    s_sub_u32 s49, s42, 5
L_pts:
    s_waitcnt vmcnt(12)
    s_barrier
    s_add_u32 s46, s70, 0
    s_cmp_lt_u32 s46, s72
    s_cselect_b32 s48, s71, 0
    s_xor_b32 s46, s46, s48
    s_lshl_b32 s46, s46, 17
    s_add_u32 s46, s46, s73
    s_add_u32 s47, s70, 2
    s_cmp_lt_u32 s47, s72
    s_cselect_b32 s48, s71, 0
    s_xor_b32 s47, s47, s48
    s_lshl_b32 s47, s47, 17
    s_add_u32 s47, s47, s73
    s_add_u32 s70, s70, 1
    s_mov_b32 m0, s44
    s_add_u32 s48, s44, 8448
    buffer_load_dwordx4 v28, s[28:31], s46 offen nt lds
    s_waitcnt vmcnt(12)
    buffer_load_dwordx4 v2, s[28:31], s46 offen offset:1056 nt lds
    s_mov_b32 m0, s48
    s_add_u32 s44, s44, 16896
    s_waitcnt vmcnt(12)
    buffer_load_dwordx4 v28, s[24:27], s47 offen nt lds
    s_waitcnt vmcnt(12)
    buffer_load_dwordx4 v2, s[24:27], s47 offen offset:1056 nt lds
    s_cmp_eq_u32 s44, s45
    s_cselect_b32 s44, s50, s44
    s_sub_u32 s49, s49, 1
    s_cmp_lg_u32 s49, 0
    s_cbranch_scc1 L_pts
L_pds:
    s_waitcnt vmcnt(12)
    s_barrier
    s_waitcnt vmcnt(8)
    s_barrier
    s_waitcnt vmcnt(4)
    s_barrier
    s_waitcnt vmcnt(0)
    s_barrier
    s_endpgm
L_pgen:
    s_add_u32 s44, s50, 16896
    s_add_u32 s45, s50, 135168
    s_mov_b32 m0, s44
    s_add_u32 s48, s44, 8448
    buffer_load_dwordx4 v28, s[24:27], s46 offen nt lds
    buffer_load_dwordx4 v2, s[24:27], s46 offen offset:1056 nt lds
    s_mov_b32 m0, s48
    s_add_u32 s44, s44, 16896
    buffer_load_dwordx4 v28, s[24:27], s47 offen nt lds
    buffer_load_dwordx4 v2, s[24:27], s47 offen offset:1056 nt lds
    s_cmp_eq_u32 s44, s45
    s_cselect_b32 s44, s50, s44
    s_mov_b32 s68, s44
    s_add_u32 s44, s44, 33792
    s_mov_b32 s19, s88
    s_add_u32 s28, s8, s19
    s_addc_u32 s29, s9, 0
    s_mov_b32 s31, 0x20000
    s_mov_b32 s30, s87
    s_add_u32 s47, s46, 262144
    s_and_b32 s42, s89, 255
    s_mov_b32 s37, s91
    s_mov_b32 s73, s86
    s_mov_b32 s70, 0
    s_sub_u32 s72, s42, 1
    s_bitcmp1_b32 s89, 13
    s_cselect_b32 s48, -4, -2
    s_and_b32 s72, s72, s48
    v_lshlrev_b32 v40, 4, v0
    s_mov_b32 s59, 0x3e0293ee
    v_mov_b32 v52, s59
    v_mov_b32 v53, s59
    v_add_u32 v41, s68, v40
    s_waitcnt vmcnt(7)
    v_lshlrev_b32 v44, 16, v112
    v_and_b32 v45, 0xffff0000, v112
    v_pk_mul_f32 v[44:45], v[44:45], v[52:53]
    v_cvt_pk_bf16_f32 v112, v44, v45
    v_lshlrev_b32 v46, 16, v113
    v_and_b32 v47, 0xffff0000, v113
    v_pk_mul_f32 v[46:47], v[46:47], v[52:53]
    v_cvt_pk_bf16_f32 v113, v46, v47
    v_lshlrev_b32 v48, 16, v114
    v_and_b32 v49, 0xffff0000, v114
    v_pk_mul_f32 v[48:49], v[48:49], v[52:53]
    v_cvt_pk_bf16_f32 v114, v48, v49
    v_lshlrev_b32 v50, 16, v115
    v_and_b32 v51, 0xffff0000, v115
    v_pk_mul_f32 v[50:51], v[50:51], v[52:53]
    v_cvt_pk_bf16_f32 v115, v50, v51
    ds_write_b128 v41, v[112:115] offset:0
    s_waitcnt vmcnt(6)
    v_lshlrev_b32 v44, 16, v116
    v_and_b32 v45, 0xffff0000, v116
    v_pk_mul_f32 v[44:45], v[44:45], v[52:53]
    v_cvt_pk_bf16_f32 v116, v44, v45
    v_lshlrev_b32 v46, 16, v117
    v_and_b32 v47, 0xffff0000, v117
    v_pk_mul_f32 v[46:47], v[46:47], v[52:53]
    v_cvt_pk_bf16_f32 v117, v46, v47
    v_lshlrev_b32 v48, 16, v118
    v_and_b32 v49, 0xffff0000, v118
    v_pk_mul_f32 v[48:49], v[48:49], v[52:53]
    v_cvt_pk_bf16_f32 v118, v48, v49
    v_lshlrev_b32 v50, 16, v119
    v_and_b32 v51, 0xffff0000, v119
    v_pk_mul_f32 v[50:51], v[50:51], v[52:53]
    v_cvt_pk_bf16_f32 v119, v50, v51
    ds_write_b128 v41, v[116:119] offset:1056
    s_add_u32 s46, s70, 0
    s_cmp_lt_u32 s46, s72
    s_cselect_b32 s48, s71, 0
    s_xor_b32 s46, s46, s48
    s_lshl_b32 s46, s46, 17
    s_add_u32 s46, s46, s73
    s_add_u32 s47, s70, 2
    s_cmp_lt_u32 s47, s72
    s_cselect_b32 s48, s71, 0
    s_xor_b32 s47, s47, s48
    s_lshl_b32 s47, s47, 17
    s_add_u32 s47, s47, s73
    s_add_u32 s70, s70, 1
    s_mov_b32 m0, s44
    s_add_u32 s48, s44, 8448
    buffer_load_dwordx4 v28, s[28:31], s46 offen nt lds
    buffer_load_dwordx4 v2, s[28:31], s46 offen offset:1056 nt lds
    s_mov_b32 m0, s48
    s_add_u32 s44, s44, 16896
    buffer_load_dwordx4 v28, s[24:27], s47 offen nt lds
    buffer_load_dwordx4 v2, s[24:27], s47 offen offset:1056 nt lds
    s_cmp_eq_u32 s44, s45
    s_cselect_b32 s44, s50, s44
    s_waitcnt vmcnt(9)
    v_lshlrev_b32 v44, 16, v120
    v_and_b32 v45, 0xffff0000, v120
    v_pk_mul_f32 v[44:45], v[44:45], v[52:53]
    v_cvt_pk_bf16_f32 v120, v44, v45
    v_lshlrev_b32 v46, 16, v121
    v_and_b32 v47, 0xffff0000, v121
    v_pk_mul_f32 v[46:47], v[46:47], v[52:53]
    v_cvt_pk_bf16_f32 v121, v46, v47
    v_lshlrev_b32 v48, 16, v122
    v_and_b32 v49, 0xffff0000, v122
    v_pk_mul_f32 v[48:49], v[48:49], v[52:53]
    v_cvt_pk_bf16_f32 v122, v48, v49
    v_lshlrev_b32 v50, 16, v123
    v_and_b32 v51, 0xffff0000, v123
    v_pk_mul_f32 v[50:51], v[50:51], v[52:53]
    v_cvt_pk_bf16_f32 v123, v50, v51
    ds_write_b128 v41, v[120:123] offset:8448
    s_waitcnt vmcnt(8)
    v_lshlrev_b32 v44, 16, v124
    v_and_b32 v45, 0xffff0000, v124
    v_pk_mul_f32 v[44:45], v[44:45], v[52:53]
    v_cvt_pk_bf16_f32 v124, v44, v45
    v_lshlrev_b32 v46, 16, v125
    v_and_b32 v47, 0xffff0000, v125
    v_pk_mul_f32 v[46:47], v[46:47], v[52:53]
    v_cvt_pk_bf16_f32 v125, v46, v47
    v_lshlrev_b32 v48, 16, v126
    v_and_b32 v49, 0xffff0000, v126
    v_pk_mul_f32 v[48:49], v[48:49], v[52:53]
    v_cvt_pk_bf16_f32 v126, v48, v49
    v_lshlrev_b32 v50, 16, v127
    v_and_b32 v51, 0xffff0000, v127
    v_pk_mul_f32 v[50:51], v[50:51], v[52:53]
    v_cvt_pk_bf16_f32 v127, v50, v51
    ds_write_b128 v41, v[124:127] offset:9504
    s_waitcnt vmcnt(4)
    s_waitcnt lgkmcnt(0)
    s_barrier
    s_add_u32 s46, s70, 0
    s_cmp_lt_u32 s46, s72
    s_cselect_b32 s48, s71, 0
    s_xor_b32 s46, s46, s48
    s_lshl_b32 s46, s46, 17
    s_add_u32 s46, s46, s73
    s_add_u32 s47, s70, 2
    s_cmp_lt_u32 s47, s72
    s_cselect_b32 s48, s71, 0
    s_xor_b32 s47, s47, s48
    s_lshl_b32 s47, s47, 17
    s_add_u32 s47, s47, s73
    s_add_u32 s70, s70, 1
    s_mov_b32 m0, s44
    s_add_u32 s48, s44, 8448
    buffer_load_dwordx4 v28, s[28:31], s46 offen nt lds
    buffer_load_dwordx4 v2, s[28:31], s46 offen offset:1056 nt lds
    s_mov_b32 m0, s48
    s_add_u32 s44, s44, 16896
    buffer_load_dwordx4 v28, s[24:27], s47 offen nt lds
    buffer_load_dwordx4 v2, s[24:27], s47 offen offset:1056 nt lds
    s_cmp_eq_u32 s44, s45
    s_cselect_b32 s44, s50, s44
    s_waitcnt vmcnt(4)
    s_barrier
    s_add_u32 s46, s70, 0
    s_cmp_lt_u32 s46, s72
    s_cselect_b32 s48, s71, 0
    s_xor_b32 s46, s46, s48
    s_lshl_b32 s46, s46, 17
    s_add_u32 s46, s46, s73
    s_add_u32 s47, s70, 2
    s_cmp_lt_u32 s47, s72
    s_cselect_b32 s48, s71, 0
    s_xor_b32 s47, s47, s48
    s_lshl_b32 s47, s47, 17
    s_add_u32 s47, s47, s73
    s_add_u32 s70, s70, 1
    s_mov_b32 m0, s44
    s_add_u32 s48, s44, 8448
    buffer_load_dwordx4 v28, s[28:31], s46 offen nt lds
    buffer_load_dwordx4 v2, s[28:31], s46 offen offset:1056 nt lds
    s_mov_b32 m0, s48
    s_add_u32 s44, s44, 16896
    buffer_load_dwordx4 v28, s[24:27], s47 offen nt lds
    buffer_load_dwordx4 v2, s[24:27], s47 offen offset:1056 nt lds
    s_cmp_eq_u32 s44, s45
    s_cselect_b32 s44, s50, s44
    s_waitcnt vmcnt(4)
    s_barrier
    s_add_u32 s46, s70, 0
    s_cmp_lt_u32 s46, s72
    s_cselect_b32 s48, s71, 0
    s_xor_b32 s46, s46, s48
    s_lshl_b32 s46, s46, 17
    s_add_u32 s46, s46, s73
    s_add_u32 s47, s70, 2
    s_cmp_lt_u32 s47, s72
    s_cselect_b32 s48, s71, 0
    s_xor_b32 s47, s47, s48
    s_lshl_b32 s47, s47, 17
    s_add_u32 s47, s47, s73
    s_add_u32 s70, s70, 1
    s_mov_b32 m0, s44
    s_add_u32 s48, s44, 8448
    buffer_load_dwordx4 v28, s[28:31], s46 offen nt lds
    buffer_load_dwordx4 v2, s[28:31], s46 offen offset:1056 nt lds
    s_mov_b32 m0, s48
    s_add_u32 s44, s44, 16896
    buffer_load_dwordx4 v28, s[24:27], s47 offen nt lds
    buffer_load_dwordx4 v2, s[24:27], s47 offen offset:1056 nt lds
    s_cmp_eq_u32 s44, s45
    s_cselect_b32 s44, s50, s44
    s_waitcnt vmcnt(4)
    s_barrier
    s_add_u32 s46, s70, 0
    s_cmp_lt_u32 s46, s72
    s_cselect_b32 s48, s71, 0
    s_xor_b32 s46, s46, s48
    s_lshl_b32 s46, s46, 17
    s_add_u32 s46, s46, s73
    s_add_u32 s47, s70, 2
    s_cmp_lt_u32 s47, s72
    s_cselect_b32 s48, s71, 0
    s_xor_b32 s47, s47, s48
    s_lshl_b32 s47, s47, 17
    s_add_u32 s47, s47, s73
    s_add_u32 s70, s70, 1
    s_mov_b32 m0, s44
    s_add_u32 s48, s44, 8448
    buffer_load_dwordx4 v28, s[28:31], s46 offen nt lds
    buffer_load_dwordx4 v2, s[28:31], s46 offen offset:1056 nt lds
    s_mov_b32 m0, s48
    s_add_u32 s44, s44, 16896
    buffer_load_dwordx4 v28, s[24:27], s47 offen nt lds
    buffer_load_dwordx4 v2, s[24:27], s47 offen offset:1056 nt lds
    s_cmp_eq_u32 s44, s45
    s_cselect_b32 s44, s50, s44
    s_waitcnt vmcnt(4)
    s_barrier
    s_add_u32 s46, s70, 0
    s_cmp_lt_u32 s46, s72
    s_cselect_b32 s48, s71, 0
    s_xor_b32 s46, s46, s48
    s_lshl_b32 s46, s46, 17
    s_add_u32 s46, s46, s73
    s_add_u32 s47, s70, 2
    s_cmp_lt_u32 s47, s72
    s_cselect_b32 s48, s71, 0
    s_xor_b32 s47, s47, s48
    s_lshl_b32 s47, s47, 17
    s_add_u32 s47, s47, s73
    s_add_u32 s70, s70, 1
    s_mov_b32 m0, s44
    s_add_u32 s48, s44, 8448
    buffer_load_dwordx4 v28, s[28:31], s46 offen nt lds
    buffer_load_dwordx4 v2, s[28:31], s46 offen offset:1056 nt lds
    s_mov_b32 m0, s48
    s_add_u32 s44, s44, 16896
    buffer_load_dwordx4 v28, s[24:27], s47 offen nt lds
    buffer_load_dwordx4 v2, s[24:27], s47 offen offset:1056 nt lds
    s_cmp_eq_u32 s44, s45
    s_cselect_b32 s44, s50, s44
    s_waitcnt vmcnt(4)
    s_barrier
    s_add_u32 s46, s70, 0
    s_cmp_lt_u32 s46, s72
    s_cselect_b32 s48, s71, 0
    s_xor_b32 s46, s46, s48
    s_lshl_b32 s46, s46, 17
    s_add_u32 s46, s46, s73
    s_add_u32 s47, s70, 2
    s_cmp_lt_u32 s47, s72
    s_cselect_b32 s48, s71, 0
    s_xor_b32 s47, s47, s48
    s_lshl_b32 s47, s47, 17
    s_add_u32 s47, s47, s73
    s_add_u32 s70, s70, 1
    s_mov_b32 m0, s44
    s_add_u32 s48, s44, 8448
    buffer_load_dwordx4 v28, s[28:31], s46 offen nt lds
    buffer_load_dwordx4 v2, s[28:31], s46 offen offset:1056 nt lds
    s_mov_b32 m0, s48
    s_add_u32 s44, s44, 16896
    buffer_load_dwordx4 v28, s[24:27], s47 offen nt lds
    buffer_load_dwordx4 v2, s[24:27], s47 offen offset:1056 nt lds
    s_cmp_eq_u32 s44, s45
    s_cselect_b32 s44, s50, s44
    s_waitcnt vmcnt(4)
    s_barrier
    s_add_u32 s46, s70, 0
    s_cmp_lt_u32 s46, s72
    s_cselect_b32 s48, s71, 0
    s_xor_b32 s46, s46, s48
    s_lshl_b32 s46, s46, 17
    s_add_u32 s46, s46, s73
    s_add_u32 s47, s70, 2
    s_cmp_lt_u32 s47, s72
    s_cselect_b32 s48, s71, 0
    s_xor_b32 s47, s47, s48
    s_lshl_b32 s47, s47, 17
    s_add_u32 s47, s47, s73
    s_add_u32 s70, s70, 1
    s_mov_b32 m0, s44
    s_add_u32 s48, s44, 8448
    buffer_load_dwordx4 v28, s[28:31], s46 offen nt lds
    buffer_load_dwordx4 v2, s[28:31], s46 offen offset:1056 nt lds
    s_mov_b32 m0, s48
    s_add_u32 s44, s44, 16896
    buffer_load_dwordx4 v28, s[24:27], s47 offen nt lds
    buffer_load_dwordx4 v2, s[24:27], s47 offen offset:1056 nt lds
    s_cmp_eq_u32 s44, s45
    s_cselect_b32 s44, s50, s44
    s_add_u32 s46, s70, 0
    s_cmp_lt_u32 s46, s72
    s_cselect_b32 s48, s71, 0
    s_xor_b32 s46, s46, s48
    s_lshl_b32 s46, s46, 17
    s_add_u32 s46, s46, s73
    s_add_u32 s47, s70, 2
    s_cmp_lt_u32 s47, s72
    s_cselect_b32 s48, s71, 0
    s_xor_b32 s47, s47, s48
    s_lshl_b32 s47, s47, 17
    s_add_u32 s47, s47, s73
    s_add_u32 s70, s70, 1
    s_mov_b32 m0, s44
    s_add_u32 s48, s44, 8448
    buffer_load_dwordx4 v28, s[28:31], s46 offen nt lds
    buffer_load_dwordx4 v2, s[28:31], s46 offen offset:1056 nt lds
    s_mov_b32 m0, s48
    s_add_u32 s44, s44, 16896
    buffer_load_dwordx4 v28, s[24:27], s47 offen nt lds
    buffer_load_dwordx4 v2, s[24:27], s47 offen offset:1056 nt lds
    s_cmp_eq_u32 s44, s45
    s_cselect_b32 s44, s50, s44
    s_waitcnt vmcnt(8)
    s_barrier
    s_add_u32 s46, s70, 0
    s_cmp_lt_u32 s46, s72
    s_cselect_b32 s48, s71, 0
    s_xor_b32 s46, s46, s48
    s_lshl_b32 s46, s46, 17
    s_add_u32 s46, s46, s73
    s_add_u32 s47, s70, 2
    s_cmp_lt_u32 s47, s72
    s_cselect_b32 s48, s71, 0
    s_xor_b32 s47, s47, s48
    s_lshl_b32 s47, s47, 17
    s_add_u32 s47, s47, s73
    s_add_u32 s70, s70, 1
    s_mov_b32 m0, s44
    s_add_u32 s48, s44, 8448
    buffer_load_dwordx4 v28, s[28:31], s46 offen nt lds
    buffer_load_dwordx4 v2, s[28:31], s46 offen offset:1056 nt lds
    s_mov_b32 m0, s48
    s_add_u32 s44, s44, 16896
    buffer_load_dwordx4 v28, s[24:27], s47 offen nt lds
    buffer_load_dwordx4 v2, s[24:27], s47 offen offset:1056 nt lds
    s_cmp_eq_u32 s44, s45
    s_cselect_b32 s44, s50, s44
    s_add_u32 s46, s70, 0
    s_cmp_lt_u32 s46, s72
    s_cselect_b32 s48, s71, 0
    s_xor_b32 s46, s46, s48
    s_lshl_b32 s46, s46, 17
    s_add_u32 s46, s46, s73
    s_add_u32 s47, s70, 2
    s_cmp_lt_u32 s47, s72
    s_cselect_b32 s48, s71, 0
    s_xor_b32 s47, s47, s48
    s_lshl_b32 s47, s47, 17
    s_add_u32 s47, s47, s73
    s_add_u32 s70, s70, 1
    s_mov_b32 m0, s44
    s_add_u32 s48, s44, 8448
    buffer_load_dwordx4 v28, s[28:31], s46 offen nt lds
    s_waitcnt vmcnt(12)
    buffer_load_dwordx4 v2, s[28:31], s46 offen offset:1056 nt lds
    s_mov_b32 m0, s48
    s_add_u32 s44, s44, 16896
    s_waitcnt vmcnt(12)
    buffer_load_dwordx4 v28, s[24:27], s47 offen nt lds
    s_waitcnt vmcnt(12)
    buffer_load_dwordx4 v2, s[24:27], s47 offen offset:1056 nt lds
    s_cmp_eq_u32 s44, s45
    s_cselect_b32 s44, s50, s44
    s_setprio 0
    s_sub_u32 s49, s42, 11
L_ptg:
    s_waitcnt vmcnt(12)
    s_barrier
    s_add_u32 s46, s70, 0
    s_cmp_lt_u32 s46, s72
    s_cselect_b32 s48, s71, 0
    s_xor_b32 s46, s46, s48
    s_lshl_b32 s46, s46, 17
    s_add_u32 s46, s46, s73
    s_add_u32 s47, s70, 2
    s_cmp_lt_u32 s47, s72
    s_cselect_b32 s48, s71, 0
    s_xor_b32 s47, s47, s48
    s_lshl_b32 s47, s47, 17
    s_add_u32 s47, s47, s73
    s_add_u32 s70, s70, 1
    s_mov_b32 m0, s44
    s_add_u32 s48, s44, 8448
    buffer_load_dwordx4 v28, s[28:31], s46 offen nt lds
    s_waitcnt vmcnt(12)
    buffer_load_dwordx4 v2, s[28:31], s46 offen offset:1056 nt lds
    s_mov_b32 m0, s48
    s_add_u32 s44, s44, 16896
    s_waitcnt vmcnt(12)
    buffer_load_dwordx4 v28, s[24:27], s47 offen nt lds
    s_waitcnt vmcnt(12)
    buffer_load_dwordx4 v2, s[24:27], s47 offen offset:1056 nt lds
    s_cmp_eq_u32 s44, s45
    s_cselect_b32 s44, s50, s44
    s_sub_u32 s49, s49, 1
    s_cmp_lg_u32 s49, 0
    s_cbranch_scc1 L_ptg
L_pdg:
    s_waitcnt vmcnt(12)
    s_barrier
    s_waitcnt vmcnt(8)
    s_barrier
    s_waitcnt vmcnt(4)
    s_barrier
    s_waitcnt vmcnt(0)
    s_barrier
    s_endpgm
L_pkp:
    s_add_u32 s44, s50, 16896
    s_add_u32 s45, s50, 135168
    s_mov_b32 m0, s44
    s_add_u32 s48, s44, 8448
    buffer_load_dwordx4 v28, s[24:27], s46 offen lds
    buffer_load_dwordx4 v2, s[24:27], s46 offen offset:1056 lds
    s_mov_b32 m0, s48
    s_add_u32 s44, s44, 16896
    buffer_load_dwordx4 v28, s[24:27], s47 offen lds
    buffer_load_dwordx4 v2, s[24:27], s47 offen offset:1056 lds
    s_cmp_eq_u32 s44, s45
    s_cselect_b32 s44, s50, s44
    s_mov_b32 s68, s44
    s_add_u32 s44, s44, 33792
    s_mov_b32 s19, s88
    s_add_u32 s28, s8, s19
    s_addc_u32 s29, s9, 0
    s_mov_b32 s31, 0x20000
    s_mov_b32 s30, s87
    s_add_u32 s47, s46, 262144
    s_and_b32 s42, s89, 255
    s_mov_b32 s37, s91
    s_mov_b32 s73, s86
    s_mov_b32 s70, 0
    s_sub_u32 s72, s42, 1
    s_bitcmp1_b32 s89, 13
    s_cselect_b32 s48, -4, -2
    s_and_b32 s72, s72, s48
    v_lshlrev_b32 v40, 4, v0
    s_mov_b32 s59, 0x3e0293ee
    v_mov_b32 v52, s59
    v_mov_b32 v53, s59
    v_add_u32 v41, s68, v40
    s_waitcnt vmcnt(7)
    v_lshlrev_b32 v44, 16, v112
    v_and_b32 v45, 0xffff0000, v112
    v_pk_mul_f32 v[44:45], v[44:45], v[52:53]
    v_cvt_pk_bf16_f32 v112, v44, v45
    v_lshlrev_b32 v46, 16, v113
    v_and_b32 v47, 0xffff0000, v113
    v_pk_mul_f32 v[46:47], v[46:47], v[52:53]
    v_cvt_pk_bf16_f32 v113, v46, v47
    v_lshlrev_b32 v48, 16, v114
    v_and_b32 v49, 0xffff0000, v114
    v_pk_mul_f32 v[48:49], v[48:49], v[52:53]
    v_cvt_pk_bf16_f32 v114, v48, v49
    v_lshlrev_b32 v50, 16, v115
    v_and_b32 v51, 0xffff0000, v115
    v_pk_mul_f32 v[50:51], v[50:51], v[52:53]
    v_cvt_pk_bf16_f32 v115, v50, v51
    ds_write_b128 v41, v[112:115] offset:0
    s_waitcnt vmcnt(6)
    v_lshlrev_b32 v44, 16, v116
    v_and_b32 v45, 0xffff0000, v116
    v_pk_mul_f32 v[44:45], v[44:45], v[52:53]
    v_cvt_pk_bf16_f32 v116, v44, v45
    v_lshlrev_b32 v46, 16, v117
    v_and_b32 v47, 0xffff0000, v117
    v_pk_mul_f32 v[46:47], v[46:47], v[52:53]
    v_cvt_pk_bf16_f32 v117, v46, v47
    v_lshlrev_b32 v48, 16, v118
    v_and_b32 v49, 0xffff0000, v118
    v_pk_mul_f32 v[48:49], v[48:49], v[52:53]
    v_cvt_pk_bf16_f32 v118, v48, v49
    v_lshlrev_b32 v50, 16, v119
    v_and_b32 v51, 0xffff0000, v119
    v_pk_mul_f32 v[50:51], v[50:51], v[52:53]
    v_cvt_pk_bf16_f32 v119, v50, v51
    ds_write_b128 v41, v[116:119] offset:1056
    s_add_u32 s46, s70, 0
    s_cmp_lt_u32 s46, s72
    s_cselect_b32 s48, s71, 0
    s_xor_b32 s46, s46, s48
    s_lshl_b32 s46, s46, 17
    s_add_u32 s46, s46, s73
    s_add_u32 s47, s70, 2
    s_cmp_lt_u32 s47, s72
    s_cselect_b32 s48, s71, 0
    s_xor_b32 s47, s47, s48
    s_lshl_b32 s47, s47, 17
    s_add_u32 s47, s47, s73
    s_add_u32 s70, s70, 1
    s_mov_b32 m0, s44
    s_add_u32 s48, s44, 8448
    buffer_load_dwordx4 v28, s[28:31], s46 offen lds
    buffer_load_dwordx4 v2, s[28:31], s46 offen offset:1056 lds
    s_mov_b32 m0, s48
    s_add_u32 s44, s44, 16896
    buffer_load_dwordx4 v28, s[24:27], s47 offen lds
    buffer_load_dwordx4 v2, s[24:27], s47 offen offset:1056 lds
    s_cmp_eq_u32 s44, s45
    s_cselect_b32 s44, s50, s44
    s_waitcnt vmcnt(9)
    v_lshlrev_b32 v44, 16, v120
    v_and_b32 v45, 0xffff0000, v120
    v_pk_mul_f32 v[44:45], v[44:45], v[52:53]
    v_cvt_pk_bf16_f32 v120, v44, v45
    v_lshlrev_b32 v46, 16, v121
    v_and_b32 v47, 0xffff0000, v121
    v_pk_mul_f32 v[46:47], v[46:47], v[52:53]
    v_cvt_pk_bf16_f32 v121, v46, v47
    v_lshlrev_b32 v48, 16, v122
    v_and_b32 v49, 0xffff0000, v122
    v_pk_mul_f32 v[48:49], v[48:49], v[52:53]
    v_cvt_pk_bf16_f32 v122, v48, v49
    v_lshlrev_b32 v50, 16, v123
    v_and_b32 v51, 0xffff0000, v123
    v_pk_mul_f32 v[50:51], v[50:51], v[52:53]
    v_cvt_pk_bf16_f32 v123, v50, v51
    ds_write_b128 v41, v[120:123] offset:8448
    s_waitcnt vmcnt(8)
    v_lshlrev_b32 v44, 16, v124
    v_and_b32 v45, 0xffff0000, v124
    v_pk_mul_f32 v[44:45], v[44:45], v[52:53]
    v_cvt_pk_bf16_f32 v124, v44, v45
    v_lshlrev_b32 v46, 16, v125
    v_and_b32 v47, 0xffff0000, v125
    v_pk_mul_f32 v[46:47], v[46:47], v[52:53]
    v_cvt_pk_bf16_f32 v125, v46, v47
    v_lshlrev_b32 v48, 16, v126
    v_and_b32 v49, 0xffff0000, v126
    v_pk_mul_f32 v[48:49], v[48:49], v[52:53]
    v_cvt_pk_bf16_f32 v126, v48, v49
    v_lshlrev_b32 v50, 16, v127
    v_and_b32 v51, 0xffff0000, v127
    v_pk_mul_f32 v[50:51], v[50:51], v[52:53]
    v_cvt_pk_bf16_f32 v127, v50, v51
    ds_write_b128 v41, v[124:127] offset:9504
    s_waitcnt vmcnt(4)
    s_waitcnt lgkmcnt(0)
    s_barrier
    s_add_u32 s46, s70, 0
    s_cmp_lt_u32 s46, s72
    s_cselect_b32 s48, s71, 0
    s_xor_b32 s46, s46, s48
    s_lshl_b32 s46, s46, 17
    s_add_u32 s46, s46, s73
    s_add_u32 s47, s70, 2
    s_cmp_lt_u32 s47, s72
    s_cselect_b32 s48, s71, 0
    s_xor_b32 s47, s47, s48
    s_lshl_b32 s47, s47, 17
    s_add_u32 s47, s47, s73
    s_add_u32 s70, s70, 1
    s_mov_b32 m0, s44
    s_add_u32 s48, s44, 8448
    buffer_load_dwordx4 v28, s[28:31], s46 offen lds
    buffer_load_dwordx4 v2, s[28:31], s46 offen offset:1056 lds
    s_mov_b32 m0, s48
    s_add_u32 s44, s44, 16896
    buffer_load_dwordx4 v28, s[24:27], s47 offen lds
    buffer_load_dwordx4 v2, s[24:27], s47 offen offset:1056 lds
    s_cmp_eq_u32 s44, s45
    s_cselect_b32 s44, s50, s44
    s_add_u32 s46, s70, 0
    s_cmp_lt_u32 s46, s72
    s_cselect_b32 s48, s71, 0
    s_xor_b32 s46, s46, s48
    s_lshl_b32 s46, s46, 17
    s_add_u32 s46, s46, s73
    s_add_u32 s47, s70, 2
    s_cmp_lt_u32 s47, s72
    s_cselect_b32 s48, s71, 0
    s_xor_b32 s47, s47, s48
    s_lshl_b32 s47, s47, 17
    s_add_u32 s47, s47, s73
    s_add_u32 s70, s70, 1
    s_mov_b32 m0, s44
    s_add_u32 s48, s44, 8448
    buffer_load_dwordx4 v28, s[28:31], s46 offen lds
    buffer_load_dwordx4 v2, s[28:31], s46 offen offset:1056 lds
    s_mov_b32 m0, s48
    s_add_u32 s44, s44, 16896
    buffer_load_dwordx4 v28, s[24:27], s47 offen lds
    buffer_load_dwordx4 v2, s[24:27], s47 offen offset:1056 lds
    s_cmp_eq_u32 s44, s45
    s_cselect_b32 s44, s50, s44
    s_waitcnt vmcnt(8)
    s_barrier
    s_add_u32 s46, s70, 0
    s_cmp_lt_u32 s46, s72
    s_cselect_b32 s48, s71, 0
    s_xor_b32 s46, s46, s48
    s_lshl_b32 s46, s46, 17
    s_add_u32 s46, s46, s73
    s_add_u32 s47, s70, 2
    s_cmp_lt_u32 s47, s72
    s_cselect_b32 s48, s71, 0
    s_xor_b32 s47, s47, s48
    s_lshl_b32 s47, s47, 17
    s_add_u32 s47, s47, s73
    s_add_u32 s70, s70, 1
    s_mov_b32 m0, s44
    s_add_u32 s48, s44, 8448
    buffer_load_dwordx4 v28, s[28:31], s46 offen lds
    buffer_load_dwordx4 v2, s[28:31], s46 offen offset:1056 lds
    s_mov_b32 m0, s48
    s_add_u32 s44, s44, 16896
    buffer_load_dwordx4 v28, s[24:27], s47 offen lds
    buffer_load_dwordx4 v2, s[24:27], s47 offen offset:1056 lds
    s_cmp_eq_u32 s44, s45
    s_cselect_b32 s44, s50, s44
    s_add_u32 s46, s70, 0
    s_cmp_lt_u32 s46, s72
    s_cselect_b32 s48, s71, 0
    s_xor_b32 s46, s46, s48
    s_lshl_b32 s46, s46, 17
    s_add_u32 s46, s46, s73
    s_add_u32 s47, s70, 2
    s_cmp_lt_u32 s47, s72
    s_cselect_b32 s48, s71, 0
    s_xor_b32 s47, s47, s48
    s_lshl_b32 s47, s47, 17
    s_add_u32 s47, s47, s73
    s_add_u32 s70, s70, 1
    s_mov_b32 m0, s44
    s_add_u32 s48, s44, 8448
    buffer_load_dwordx4 v28, s[28:31], s46 offen lds
    s_waitcnt vmcnt(12)
    buffer_load_dwordx4 v2, s[28:31], s46 offen offset:1056 lds
    s_mov_b32 m0, s48
    s_add_u32 s44, s44, 16896
    s_waitcnt vmcnt(12)
    buffer_load_dwordx4 v28, s[24:27], s47 offen lds
    s_waitcnt vmcnt(12)
    buffer_load_dwordx4 v2, s[24:27], s47 offen offset:1056 lds
    s_cmp_eq_u32 s44, s45
    s_cselect_b32 s44, s50, s44
    s_setprio 0
    s_sub_u32 s49, s42, 5
L_ptp:
    s_waitcnt vmcnt(12)
    s_barrier
    s_add_u32 s46, s70, 0
    s_cmp_lt_u32 s46, s72
    s_cselect_b32 s48, s71, 0
    s_xor_b32 s46, s46, s48
    s_lshl_b32 s46, s46, 17
    s_add_u32 s46, s46, s73
    s_add_u32 s47, s70, 2
    s_cmp_lt_u32 s47, s72
    s_cselect_b32 s48, s71, 0
    s_xor_b32 s47, s47, s48
    s_lshl_b32 s47, s47, 17
    s_add_u32 s47, s47, s73
    s_add_u32 s70, s70, 1
    s_mov_b32 m0, s44
    s_add_u32 s48, s44, 8448
    buffer_load_dwordx4 v28, s[28:31], s46 offen lds
    s_waitcnt vmcnt(12)
    buffer_load_dwordx4 v2, s[28:31], s46 offen offset:1056 lds
    s_mov_b32 m0, s48
    s_add_u32 s44, s44, 16896
    s_waitcnt vmcnt(12)
    buffer_load_dwordx4 v28, s[24:27], s47 offen lds
    s_waitcnt vmcnt(12)
    buffer_load_dwordx4 v2, s[24:27], s47 offen offset:1056 lds
    s_cmp_eq_u32 s44, s45
    s_cselect_b32 s44, s50, s44
    s_sub_u32 s49, s49, 1
    s_cmp_lg_u32 s49, 0
    s_cbranch_scc1 L_ptp
L_pdp:
    s_waitcnt vmcnt(12)
    s_barrier
    s_waitcnt vmcnt(8)
    s_barrier
    s_waitcnt vmcnt(4)
    s_barrier
    s_waitcnt vmcnt(0)
    s_barrier
    s_endpgm
L_pkeep:
    s_bitcmp1_b32 s89, 14
    s_cbranch_scc1 L_pkp
    s_add_u32 s44, s50, 16896
    s_add_u32 s45, s50, 135168
    s_mov_b32 m0, s44
    s_add_u32 s48, s44, 8448
    buffer_load_dwordx4 v28, s[24:27], s46 offen lds
    buffer_load_dwordx4 v2, s[24:27], s46 offen offset:1056 lds
    s_mov_b32 m0, s48
    s_add_u32 s44, s44, 16896
    buffer_load_dwordx4 v28, s[24:27], s47 offen lds
    buffer_load_dwordx4 v2, s[24:27], s47 offen offset:1056 lds
    s_cmp_eq_u32 s44, s45
    s_cselect_b32 s44, s50, s44
    s_mov_b32 s68, s44
    s_add_u32 s44, s44, 33792
    s_mov_b32 s19, s88
    s_add_u32 s28, s8, s19
    s_addc_u32 s29, s9, 0
    s_mov_b32 s31, 0x20000
    s_mov_b32 s30, s87
    s_add_u32 s47, s46, 262144
    s_and_b32 s42, s89, 255
    s_mov_b32 s37, s91
    s_mov_b32 s73, s86
    s_mov_b32 s70, 0
    s_sub_u32 s72, s42, 1
    s_bitcmp1_b32 s89, 13
    s_cselect_b32 s48, -4, -2
    s_and_b32 s72, s72, s48
    v_lshlrev_b32 v40, 4, v0
    s_mov_b32 s59, 0x3e0293ee
    v_mov_b32 v52, s59
    v_mov_b32 v53, s59
    v_add_u32 v41, s68, v40
    s_waitcnt vmcnt(7)
    v_lshlrev_b32 v44, 16, v112
    v_and_b32 v45, 0xffff0000, v112
    v_pk_mul_f32 v[44:45], v[44:45], v[52:53]
    v_cvt_pk_bf16_f32 v112, v44, v45
    v_lshlrev_b32 v46, 16, v113
    v_and_b32 v47, 0xffff0000, v113
    v_pk_mul_f32 v[46:47], v[46:47], v[52:53]
    v_cvt_pk_bf16_f32 v113, v46, v47
    v_lshlrev_b32 v48, 16, v114
    v_and_b32 v49, 0xffff0000, v114
    v_pk_mul_f32 v[48:49], v[48:49], v[52:53]
    v_cvt_pk_bf16_f32 v114, v48, v49
    v_lshlrev_b32 v50, 16, v115
    v_and_b32 v51, 0xffff0000, v115
    v_pk_mul_f32 v[50:51], v[50:51], v[52:53]
    v_cvt_pk_bf16_f32 v115, v50, v51
    ds_write_b128 v41, v[112:115] offset:0
    s_waitcnt vmcnt(6)
    v_lshlrev_b32 v44, 16, v116
    v_and_b32 v45, 0xffff0000, v116
    v_pk_mul_f32 v[44:45], v[44:45], v[52:53]
    v_cvt_pk_bf16_f32 v116, v44, v45
    v_lshlrev_b32 v46, 16, v117
    v_and_b32 v47, 0xffff0000, v117
    v_pk_mul_f32 v[46:47], v[46:47], v[52:53]
    v_cvt_pk_bf16_f32 v117, v46, v47
    v_lshlrev_b32 v48, 16, v118
    v_and_b32 v49, 0xffff0000, v118
    v_pk_mul_f32 v[48:49], v[48:49], v[52:53]
    v_cvt_pk_bf16_f32 v118, v48, v49
    v_lshlrev_b32 v50, 16, v119
    v_and_b32 v51, 0xffff0000, v119
    v_pk_mul_f32 v[50:51], v[50:51], v[52:53]
    v_cvt_pk_bf16_f32 v119, v50, v51
    ds_write_b128 v41, v[116:119] offset:1056
    s_add_u32 s46, s70, 0
    s_cmp_lt_u32 s46, s72
    s_cselect_b32 s48, s71, 0
    s_xor_b32 s46, s46, s48
    s_lshl_b32 s46, s46, 17
    s_add_u32 s46, s46, s73
    s_add_u32 s47, s70, 2
    s_cmp_lt_u32 s47, s72
    s_cselect_b32 s48, s71, 0
    s_xor_b32 s47, s47, s48
    s_lshl_b32 s47, s47, 17
    s_add_u32 s47, s47, s73
    s_add_u32 s70, s70, 1
    s_mov_b32 m0, s44
    s_add_u32 s48, s44, 8448
    buffer_load_dwordx4 v28, s[28:31], s46 offen lds
    buffer_load_dwordx4 v2, s[28:31], s46 offen offset:1056 lds
    s_mov_b32 m0, s48
    s_add_u32 s44, s44, 16896
    buffer_load_dwordx4 v28, s[24:27], s47 offen lds
    buffer_load_dwordx4 v2, s[24:27], s47 offen offset:1056 lds
    s_cmp_eq_u32 s44, s45
    s_cselect_b32 s44, s50, s44
    s_waitcnt vmcnt(9)
    v_lshlrev_b32 v44, 16, v120
    v_and_b32 v45, 0xffff0000, v120
    v_pk_mul_f32 v[44:45], v[44:45], v[52:53]
    v_cvt_pk_bf16_f32 v120, v44, v45
    v_lshlrev_b32 v46, 16, v121
    v_and_b32 v47, 0xffff0000, v121
    v_pk_mul_f32 v[46:47], v[46:47], v[52:53]
    v_cvt_pk_bf16_f32 v121, v46, v47
    v_lshlrev_b32 v48, 16, v122
    v_and_b32 v49, 0xffff0000, v122
    v_pk_mul_f32 v[48:49], v[48:49], v[52:53]
    v_cvt_pk_bf16_f32 v122, v48, v49
    v_lshlrev_b32 v50, 16, v123
    v_and_b32 v51, 0xffff0000, v123
    v_pk_mul_f32 v[50:51], v[50:51], v[52:53]
    v_cvt_pk_bf16_f32 v123, v50, v51
    ds_write_b128 v41, v[120:123] offset:8448
    s_waitcnt vmcnt(8)
    v_lshlrev_b32 v44, 16, v124
    v_and_b32 v45, 0xffff0000, v124
    v_pk_mul_f32 v[44:45], v[44:45], v[52:53]
    v_cvt_pk_bf16_f32 v124, v44, v45
    v_lshlrev_b32 v46, 16, v125
    v_and_b32 v47, 0xffff0000, v125
    v_pk_mul_f32 v[46:47], v[46:47], v[52:53]
    v_cvt_pk_bf16_f32 v125, v46, v47
    v_lshlrev_b32 v48, 16, v126
    v_and_b32 v49, 0xffff0000, v126
    v_pk_mul_f32 v[48:49], v[48:49], v[52:53]
    v_cvt_pk_bf16_f32 v126, v48, v49
    v_lshlrev_b32 v50, 16, v127
    v_and_b32 v51, 0xffff0000, v127
    v_pk_mul_f32 v[50:51], v[50:51], v[52:53]
    v_cvt_pk_bf16_f32 v127, v50, v51
    ds_write_b128 v41, v[124:127] offset:9504
    s_waitcnt vmcnt(4)
    s_waitcnt lgkmcnt(0)
    s_barrier
    s_add_u32 s46, s70, 0
    s_cmp_lt_u32 s46, s72
    s_cselect_b32 s48, s71, 0
    s_xor_b32 s46, s46, s48
    s_lshl_b32 s46, s46, 17
    s_add_u32 s46, s46, s73
    s_add_u32 s47, s70, 2
    s_cmp_lt_u32 s47, s72
    s_cselect_b32 s48, s71, 0
    s_xor_b32 s47, s47, s48
    s_lshl_b32 s47, s47, 17
    s_add_u32 s47, s47, s73
    s_add_u32 s70, s70, 1
    s_mov_b32 m0, s44
    s_add_u32 s48, s44, 8448
    buffer_load_dwordx4 v28, s[28:31], s46 offen lds
    buffer_load_dwordx4 v2, s[28:31], s46 offen offset:1056 lds
    s_mov_b32 m0, s48
    s_add_u32 s44, s44, 16896
    buffer_load_dwordx4 v28, s[24:27], s47 offen lds
    buffer_load_dwordx4 v2, s[24:27], s47 offen offset:1056 lds
    s_cmp_eq_u32 s44, s45
    s_cselect_b32 s44, s50, s44
    s_add_u32 s46, s70, 0
    s_cmp_lt_u32 s46, s72
    s_cselect_b32 s48, s71, 0
    s_xor_b32 s46, s46, s48
    s_lshl_b32 s46, s46, 17
    s_add_u32 s46, s46, s73
    s_add_u32 s47, s70, 2
    s_cmp_lt_u32 s47, s72
    s_cselect_b32 s48, s71, 0
    s_xor_b32 s47, s47, s48
    s_lshl_b32 s47, s47, 17
    s_add_u32 s47, s47, s73
    s_add_u32 s70, s70, 1
    s_mov_b32 m0, s44
    s_add_u32 s48, s44, 8448
    buffer_load_dwordx4 v28, s[28:31], s46 offen lds
    buffer_load_dwordx4 v2, s[28:31], s46 offen offset:1056 lds
    s_mov_b32 m0, s48
    s_add_u32 s44, s44, 16896
    buffer_load_dwordx4 v28, s[24:27], s47 offen lds
    buffer_load_dwordx4 v2, s[24:27], s47 offen offset:1056 lds
    s_cmp_eq_u32 s44, s45
    s_cselect_b32 s44, s50, s44
    s_waitcnt vmcnt(8)
    s_barrier
    s_add_u32 s46, s70, 0
    s_cmp_lt_u32 s46, s72
    s_cselect_b32 s48, s71, 0
    s_xor_b32 s46, s46, s48
    s_lshl_b32 s46, s46, 17
    s_add_u32 s46, s46, s73
    s_add_u32 s47, s70, 2
    s_cmp_lt_u32 s47, s72
    s_cselect_b32 s48, s71, 0
    s_xor_b32 s47, s47, s48
    s_lshl_b32 s47, s47, 17
    s_add_u32 s47, s47, s73
    s_add_u32 s70, s70, 1
    s_mov_b32 m0, s44
    s_add_u32 s48, s44, 8448
    buffer_load_dwordx4 v28, s[28:31], s46 offen lds
    buffer_load_dwordx4 v2, s[28:31], s46 offen offset:1056 lds
    s_mov_b32 m0, s48
    s_add_u32 s44, s44, 16896
    buffer_load_dwordx4 v28, s[24:27], s47 offen lds
    buffer_load_dwordx4 v2, s[24:27], s47 offen offset:1056 lds
    s_cmp_eq_u32 s44, s45
    s_cselect_b32 s44, s50, s44
    s_add_u32 s46, s70, 0
    s_cmp_lt_u32 s46, s72
    s_cselect_b32 s48, s71, 0
    s_xor_b32 s46, s46, s48
    s_lshl_b32 s46, s46, 17
    s_add_u32 s46, s46, s73
    s_add_u32 s47, s70, 2
    s_cmp_lt_u32 s47, s72
    s_cselect_b32 s48, s71, 0
    s_xor_b32 s47, s47, s48
    s_lshl_b32 s47, s47, 17
    s_add_u32 s47, s47, s73
    s_add_u32 s70, s70, 1
    s_mov_b32 m0, s44
    s_add_u32 s48, s44, 8448
    buffer_load_dwordx4 v28, s[28:31], s46 offen lds
    s_waitcnt vmcnt(12)
    buffer_load_dwordx4 v2, s[28:31], s46 offen offset:1056 lds
    s_mov_b32 m0, s48
    s_add_u32 s44, s44, 16896
    s_waitcnt vmcnt(12)
    buffer_load_dwordx4 v28, s[24:27], s47 offen lds
    s_waitcnt vmcnt(12)
    buffer_load_dwordx4 v2, s[24:27], s47 offen offset:1056 lds
    s_cmp_eq_u32 s44, s45
    s_cselect_b32 s44, s50, s44
    s_setprio 0
    s_sub_u32 s49, s42, 5
L_ptk:
    s_cmp_eq_u32 s49, 0
    s_cbranch_scc1 L_pek
    s_waitcnt vmcnt(12)
    s_barrier
    s_add_u32 s46, s70, 0
    s_cmp_lt_u32 s46, s72
    s_cselect_b32 s48, s71, 0
    s_xor_b32 s46, s46, s48
    s_lshl_b32 s46, s46, 17
    s_add_u32 s46, s46, s73
    s_add_u32 s47, s70, 2
    s_cmp_lt_u32 s47, s72
    s_cselect_b32 s48, s71, 0
    s_xor_b32 s47, s47, s48
    s_lshl_b32 s47, s47, 17
    s_add_u32 s47, s47, s73
    s_add_u32 s70, s70, 1
    s_mov_b32 m0, s44
    s_add_u32 s48, s44, 8448
    buffer_load_dwordx4 v28, s[28:31], s46 offen lds
    s_waitcnt vmcnt(12)
    buffer_load_dwordx4 v2, s[28:31], s46 offen offset:1056 lds
    s_mov_b32 m0, s48
    s_add_u32 s44, s44, 16896
    s_waitcnt vmcnt(12)
    buffer_load_dwordx4 v28, s[24:27], s47 offen lds
    s_waitcnt vmcnt(12)
    buffer_load_dwordx4 v2, s[24:27], s47 offen offset:1056 lds
    s_cmp_eq_u32 s44, s45
    s_cselect_b32 s44, s50, s44
    s_sub_u32 s49, s49, 1
    s_branch L_ptk
L_pek:
    s_cmp_eq_u32 s37, 0
    s_cbranch_scc1 L_pdk
    s_bitcmp1_b32 s42, 0
    s_cbranch_scc1 L_pc1k
    s_waitcnt vmcnt(12)
    s_barrier
    s_mov_b32 s36, s37
    s_mov_b32 s37, 0
    s_and_b32 s39, s36, 0xfff
    s_bfe_u32 s40, s36, 0x9000c
    s_bfe_u32 s41, s36, 0x20015
    s_lshl_b32 s41, s41, 7
    s_add_u32 s41, s41, s39
    s_add_u32 s42, s40, 31
    s_lshr_b32 s42, s42, 5
    s_add_u32 s43, s39, s40
    s_lshl_b32 s43, s43, 12
    s_sub_u32 s43, s43, 3584
    s_mov_b32 s22, s43
    s_lshl_b32 s74, s41, 12
    s_add_u32 s75, s74, 131072
    s_add_u32 s76, s74, 262144
    s_add_u32 s77, s74, 393216
    buffer_load_dwordx4 v[64:67], v28, s[20:23], s74 offen nt
    s_waitcnt vmcnt(12)
    buffer_load_dwordx4 v[68:71], v29, s[20:23], s74 offen nt
    s_waitcnt vmcnt(12)
    buffer_load_dwordx4 v[72:75], v28, s[20:23], s75 offen nt
    s_waitcnt vmcnt(12)
    buffer_load_dwordx4 v[76:79], v29, s[20:23], s75 offen nt
    s_waitcnt vmcnt(12)
    s_barrier
    buffer_load_dwordx4 v[80:83], v28, s[20:23], s76 offen nt
    s_waitcnt vmcnt(12)
    buffer_load_dwordx4 v[84:87], v29, s[20:23], s76 offen nt
    s_waitcnt vmcnt(12)
    buffer_load_dwordx4 v[88:91], v28, s[20:23], s77 offen nt
    s_waitcnt vmcnt(12)
    buffer_load_dwordx4 v[92:95], v29, s[20:23], s77 offen nt
    s_waitcnt vmcnt(12)
    s_barrier
    s_mov_b32 s26, s43
    s_mov_b32 s30, s43
    s_lshl_b32 s46, s39, 12
    s_add_u32 s47, s46, 131072
    s_add_u32 s44, s44, 16896
    s_cmp_eq_u32 s44, s45
    s_cselect_b32 s44, s50, s44
    s_mov_b32 s71, 0
    s_mov_b32 m0, s44
    s_add_u32 s48, s44, 8448
    buffer_load_dwordx4 v28, s[24:27], s46 offen nt lds
    s_waitcnt vmcnt(12)
    buffer_load_dwordx4 v2, s[24:27], s46 offen offset:1056 nt lds
    s_mov_b32 m0, s48
    s_add_u32 s44, s44, 16896
    s_waitcnt vmcnt(12)
    buffer_load_dwordx4 v28, s[24:27], s47 offen nt lds
    s_waitcnt vmcnt(12)
    buffer_load_dwordx4 v2, s[24:27], s47 offen offset:1056 nt lds
    s_cmp_eq_u32 s44, s45
    s_cselect_b32 s44, s50, s44
    s_lshl_b32 s73, s39, 12
    s_mov_b32 s70, 0
    s_mov_b32 s68, s44
    s_add_u32 s44, s44, 16896
    s_cmp_eq_u32 s44, s45
    s_cselect_b32 s44, s50, s44
    s_mov_b32 s69, s44
    s_add_u32 s44, s44, 16896
    s_cmp_eq_u32 s44, s45
    s_cselect_b32 s44, s50, s44
    s_waitcnt vmcnt(12)
    s_barrier
    s_add_u32 s46, s70, 0
    s_cmp_lt_u32 s46, s72
    s_cselect_b32 s48, s71, 0
    s_xor_b32 s46, s46, s48
    s_lshl_b32 s46, s46, 17
    s_add_u32 s46, s46, s73
    s_add_u32 s47, s70, 2
    s_cmp_lt_u32 s47, s72
    s_cselect_b32 s48, s71, 0
    s_xor_b32 s47, s47, s48
    s_lshl_b32 s47, s47, 17
    s_add_u32 s47, s47, s73
    s_add_u32 s70, s70, 1
    s_mov_b32 m0, s44
    s_add_u32 s48, s44, 8448
    buffer_load_dwordx4 v28, s[28:31], s46 offen nt lds
    s_waitcnt vmcnt(12)
    buffer_load_dwordx4 v2, s[28:31], s46 offen offset:1056 nt lds
    s_mov_b32 m0, s48
    s_add_u32 s44, s44, 16896
    s_waitcnt vmcnt(12)
    buffer_load_dwordx4 v28, s[24:27], s47 offen nt lds
    s_waitcnt vmcnt(12)
    buffer_load_dwordx4 v2, s[24:27], s47 offen offset:1056 nt lds
    s_cmp_eq_u32 s44, s45
    s_cselect_b32 s44, s50, s44
    s_add_u32 s46, s70, 0
    s_cmp_lt_u32 s46, s72
    s_cselect_b32 s48, s71, 0
    s_xor_b32 s46, s46, s48
    s_lshl_b32 s46, s46, 17
    s_add_u32 s46, s46, s73
    s_add_u32 s47, s70, 2
    s_cmp_lt_u32 s47, s72
    s_cselect_b32 s48, s71, 0
    s_xor_b32 s47, s47, s48
    s_lshl_b32 s47, s47, 17
    s_add_u32 s47, s47, s73
    s_add_u32 s70, s70, 1
    s_mov_b32 m0, s44
    s_add_u32 s48, s44, 8448
    s_waitcnt vmcnt(12)
    buffer_load_dwordx4 v28, s[28:31], s46 offen nt lds
    s_waitcnt vmcnt(12)
    buffer_load_dwordx4 v2, s[28:31], s46 offen offset:1056 nt lds
    s_mov_b32 m0, s48
    s_add_u32 s44, s44, 16896
    s_waitcnt vmcnt(12)
    buffer_load_dwordx4 v28, s[24:27], s47 offen nt lds
    s_waitcnt vmcnt(12)
    buffer_load_dwordx4 v2, s[24:27], s47 offen offset:1056 nt lds
    s_cmp_eq_u32 s44, s45
    s_cselect_b32 s44, s50, s44
    v_add_u32 v41, s68, v40
    v_lshlrev_b32 v44, 16, v64
    v_and_b32 v45, 0xffff0000, v64
    v_pk_mul_f32 v[44:45], v[44:45], v[52:53]
    v_cvt_pk_bf16_f32 v64, v44, v45
    v_lshlrev_b32 v46, 16, v65
    v_and_b32 v47, 0xffff0000, v65
    v_pk_mul_f32 v[46:47], v[46:47], v[52:53]
    v_cvt_pk_bf16_f32 v65, v46, v47
    v_lshlrev_b32 v48, 16, v66
    v_and_b32 v49, 0xffff0000, v66
    v_pk_mul_f32 v[48:49], v[48:49], v[52:53]
    v_cvt_pk_bf16_f32 v66, v48, v49
    v_lshlrev_b32 v50, 16, v67
    v_and_b32 v51, 0xffff0000, v67
    v_pk_mul_f32 v[50:51], v[50:51], v[52:53]
    v_cvt_pk_bf16_f32 v67, v50, v51
    ds_write_b128 v41, v[64:67] offset:0
    v_lshlrev_b32 v44, 16, v68
    v_and_b32 v45, 0xffff0000, v68
    v_pk_mul_f32 v[44:45], v[44:45], v[52:53]
    v_cvt_pk_bf16_f32 v68, v44, v45
    v_lshlrev_b32 v46, 16, v69
    v_and_b32 v47, 0xffff0000, v69
    v_pk_mul_f32 v[46:47], v[46:47], v[52:53]
    v_cvt_pk_bf16_f32 v69, v46, v47
    v_lshlrev_b32 v48, 16, v70
    v_and_b32 v49, 0xffff0000, v70
    v_pk_mul_f32 v[48:49], v[48:49], v[52:53]
    v_cvt_pk_bf16_f32 v70, v48, v49
    v_lshlrev_b32 v50, 16, v71
    v_and_b32 v51, 0xffff0000, v71
    v_pk_mul_f32 v[50:51], v[50:51], v[52:53]
    v_cvt_pk_bf16_f32 v71, v50, v51
    ds_write_b128 v41, v[68:71] offset:1056
    v_lshlrev_b32 v44, 16, v72
    v_and_b32 v45, 0xffff0000, v72
    v_pk_mul_f32 v[44:45], v[44:45], v[52:53]
    v_cvt_pk_bf16_f32 v72, v44, v45
    v_lshlrev_b32 v46, 16, v73
    v_and_b32 v47, 0xffff0000, v73
    v_pk_mul_f32 v[46:47], v[46:47], v[52:53]
    v_cvt_pk_bf16_f32 v73, v46, v47
    v_lshlrev_b32 v48, 16, v74
    v_and_b32 v49, 0xffff0000, v74
    v_pk_mul_f32 v[48:49], v[48:49], v[52:53]
    v_cvt_pk_bf16_f32 v74, v48, v49
    v_lshlrev_b32 v50, 16, v75
    v_and_b32 v51, 0xffff0000, v75
    v_pk_mul_f32 v[50:51], v[50:51], v[52:53]
    v_cvt_pk_bf16_f32 v75, v50, v51
    ds_write_b128 v41, v[72:75] offset:8448
    v_lshlrev_b32 v44, 16, v76
    v_and_b32 v45, 0xffff0000, v76
    v_pk_mul_f32 v[44:45], v[44:45], v[52:53]
    v_cvt_pk_bf16_f32 v76, v44, v45
    v_lshlrev_b32 v46, 16, v77
    v_and_b32 v47, 0xffff0000, v77
    v_pk_mul_f32 v[46:47], v[46:47], v[52:53]
    v_cvt_pk_bf16_f32 v77, v46, v47
    v_lshlrev_b32 v48, 16, v78
    v_and_b32 v49, 0xffff0000, v78
    v_pk_mul_f32 v[48:49], v[48:49], v[52:53]
    v_cvt_pk_bf16_f32 v78, v48, v49
    v_lshlrev_b32 v50, 16, v79
    v_and_b32 v51, 0xffff0000, v79
    v_pk_mul_f32 v[50:51], v[50:51], v[52:53]
    v_cvt_pk_bf16_f32 v79, v50, v51
    ds_write_b128 v41, v[76:79] offset:9504
    v_add_u32 v41, s69, v40
    s_waitcnt vmcnt(12)
    v_lshlrev_b32 v44, 16, v80
    v_and_b32 v45, 0xffff0000, v80
    v_pk_mul_f32 v[44:45], v[44:45], v[52:53]
    v_cvt_pk_bf16_f32 v80, v44, v45
    v_lshlrev_b32 v46, 16, v81
    v_and_b32 v47, 0xffff0000, v81
    v_pk_mul_f32 v[46:47], v[46:47], v[52:53]
    v_cvt_pk_bf16_f32 v81, v46, v47
    v_lshlrev_b32 v48, 16, v82
    v_and_b32 v49, 0xffff0000, v82
    v_pk_mul_f32 v[48:49], v[48:49], v[52:53]
    v_cvt_pk_bf16_f32 v82, v48, v49
    v_lshlrev_b32 v50, 16, v83
    v_and_b32 v51, 0xffff0000, v83
    v_pk_mul_f32 v[50:51], v[50:51], v[52:53]
    v_cvt_pk_bf16_f32 v83, v50, v51
    ds_write_b128 v41, v[80:83] offset:0
    v_lshlrev_b32 v44, 16, v84
    v_and_b32 v45, 0xffff0000, v84
    v_pk_mul_f32 v[44:45], v[44:45], v[52:53]
    v_cvt_pk_bf16_f32 v84, v44, v45
    v_lshlrev_b32 v46, 16, v85
    v_and_b32 v47, 0xffff0000, v85
    v_pk_mul_f32 v[46:47], v[46:47], v[52:53]
    v_cvt_pk_bf16_f32 v85, v46, v47
    v_lshlrev_b32 v48, 16, v86
    v_and_b32 v49, 0xffff0000, v86
    v_pk_mul_f32 v[48:49], v[48:49], v[52:53]
    v_cvt_pk_bf16_f32 v86, v48, v49
    v_lshlrev_b32 v50, 16, v87
    v_and_b32 v51, 0xffff0000, v87
    v_pk_mul_f32 v[50:51], v[50:51], v[52:53]
    v_cvt_pk_bf16_f32 v87, v50, v51
    ds_write_b128 v41, v[84:87] offset:1056
    v_lshlrev_b32 v44, 16, v88
    v_and_b32 v45, 0xffff0000, v88
    v_pk_mul_f32 v[44:45], v[44:45], v[52:53]
    v_cvt_pk_bf16_f32 v88, v44, v45
    v_lshlrev_b32 v46, 16, v89
    v_and_b32 v47, 0xffff0000, v89
    v_pk_mul_f32 v[46:47], v[46:47], v[52:53]
    v_cvt_pk_bf16_f32 v89, v46, v47
    v_lshlrev_b32 v48, 16, v90
    v_and_b32 v49, 0xffff0000, v90
    v_pk_mul_f32 v[48:49], v[48:49], v[52:53]
    v_cvt_pk_bf16_f32 v90, v48, v49
    v_lshlrev_b32 v50, 16, v91
    v_and_b32 v51, 0xffff0000, v91
    v_pk_mul_f32 v[50:51], v[50:51], v[52:53]
    v_cvt_pk_bf16_f32 v91, v50, v51
    ds_write_b128 v41, v[88:91] offset:8448
    v_lshlrev_b32 v44, 16, v92
    v_and_b32 v45, 0xffff0000, v92
    v_pk_mul_f32 v[44:45], v[44:45], v[52:53]
    v_cvt_pk_bf16_f32 v92, v44, v45
    v_lshlrev_b32 v46, 16, v93
    v_and_b32 v47, 0xffff0000, v93
    v_pk_mul_f32 v[46:47], v[46:47], v[52:53]
    v_cvt_pk_bf16_f32 v93, v46, v47
    v_lshlrev_b32 v48, 16, v94
    v_and_b32 v49, 0xffff0000, v94
    v_pk_mul_f32 v[48:49], v[48:49], v[52:53]
    v_cvt_pk_bf16_f32 v94, v48, v49
    v_lshlrev_b32 v50, 16, v95
    v_and_b32 v51, 0xffff0000, v95
    v_pk_mul_f32 v[50:51], v[50:51], v[52:53]
    v_cvt_pk_bf16_f32 v95, v50, v51
    ds_write_b128 v41, v[92:95] offset:9504
    s_waitcnt vmcnt(8)
    s_waitcnt lgkmcnt(0)
    s_barrier
    s_add_u32 s46, s70, 0
    s_cmp_lt_u32 s46, s72
    s_cselect_b32 s48, s71, 0
    s_xor_b32 s46, s46, s48
    s_lshl_b32 s46, s46, 17
    s_add_u32 s46, s46, s73
    s_add_u32 s47, s70, 2
    s_cmp_lt_u32 s47, s72
    s_cselect_b32 s48, s71, 0
    s_xor_b32 s47, s47, s48
    s_lshl_b32 s47, s47, 17
    s_add_u32 s47, s47, s73
    s_add_u32 s70, s70, 1
    s_mov_b32 m0, s44
    s_add_u32 s48, s44, 8448
    buffer_load_dwordx4 v28, s[28:31], s46 offen nt lds
    buffer_load_dwordx4 v2, s[28:31], s46 offen offset:1056 nt lds
    s_mov_b32 m0, s48
    s_add_u32 s44, s44, 16896
    buffer_load_dwordx4 v28, s[24:27], s47 offen nt lds
    buffer_load_dwordx4 v2, s[24:27], s47 offen offset:1056 nt lds
    s_cmp_eq_u32 s44, s45
    s_cselect_b32 s44, s50, s44
    s_add_u32 s46, s70, 0
    s_cmp_lt_u32 s46, s72
    s_cselect_b32 s48, s71, 0
    s_xor_b32 s46, s46, s48
    s_lshl_b32 s46, s46, 17
    s_add_u32 s46, s46, s73
    s_add_u32 s47, s70, 2
    s_cmp_lt_u32 s47, s72
    s_cselect_b32 s48, s71, 0
    s_xor_b32 s47, s47, s48
    s_lshl_b32 s47, s47, 17
    s_add_u32 s47, s47, s73
    s_add_u32 s70, s70, 1
    s_mov_b32 m0, s44
    s_add_u32 s48, s44, 8448
    buffer_load_dwordx4 v28, s[28:31], s46 offen nt lds
    s_waitcnt vmcnt(12)
    buffer_load_dwordx4 v2, s[28:31], s46 offen offset:1056 nt lds
    s_mov_b32 m0, s48
    s_add_u32 s44, s44, 16896
    s_waitcnt vmcnt(12)
    buffer_load_dwordx4 v28, s[24:27], s47 offen nt lds
    s_waitcnt vmcnt(12)
    buffer_load_dwordx4 v2, s[24:27], s47 offen offset:1056 nt lds
    s_cmp_eq_u32 s44, s45
    s_cselect_b32 s44, s50, s44
    s_branch L_pdk
L_pc1k:
    s_waitcnt vmcnt(12)
    s_barrier
    s_mov_b32 s36, s37
    s_mov_b32 s37, 0
    s_and_b32 s39, s36, 0xfff
    s_bfe_u32 s40, s36, 0x9000c
    s_bfe_u32 s41, s36, 0x20015
    s_lshl_b32 s41, s41, 7
    s_add_u32 s41, s41, s39
    s_add_u32 s42, s40, 31
    s_lshr_b32 s42, s42, 5
    s_add_u32 s43, s39, s40
    s_lshl_b32 s43, s43, 12
    s_sub_u32 s43, s43, 3584
    s_mov_b32 s22, s43
    s_lshl_b32 s74, s41, 12
    s_add_u32 s75, s74, 131072
    s_add_u32 s76, s74, 262144
    s_add_u32 s77, s74, 393216
    buffer_load_dwordx4 v[64:67], v28, s[20:23], s74 offen nt
    s_waitcnt vmcnt(12)
    buffer_load_dwordx4 v[68:71], v29, s[20:23], s74 offen nt
    s_waitcnt vmcnt(12)
    buffer_load_dwordx4 v[72:75], v28, s[20:23], s75 offen nt
    s_waitcnt vmcnt(12)
    buffer_load_dwordx4 v[76:79], v29, s[20:23], s75 offen nt
    s_waitcnt vmcnt(12)
    s_barrier
    buffer_load_dwordx4 v[80:83], v28, s[20:23], s76 offen nt
    s_waitcnt vmcnt(12)
    buffer_load_dwordx4 v[84:87], v29, s[20:23], s76 offen nt
    s_waitcnt vmcnt(12)
    buffer_load_dwordx4 v[88:91], v28, s[20:23], s77 offen nt
    s_waitcnt vmcnt(12)
    buffer_load_dwordx4 v[92:95], v29, s[20:23], s77 offen nt
    s_waitcnt vmcnt(12)
    s_barrier
    s_mov_b32 s26, s43
    s_mov_b32 s30, s43
    s_lshl_b32 s46, s39, 12
    s_add_u32 s47, s46, 131072
    s_mov_b32 s71, 0
    s_mov_b32 m0, s44
    s_add_u32 s48, s44, 8448
    buffer_load_dwordx4 v28, s[24:27], s46 offen nt lds
    s_waitcnt vmcnt(12)
    buffer_load_dwordx4 v2, s[24:27], s46 offen offset:1056 nt lds
    s_mov_b32 m0, s48
    s_add_u32 s44, s44, 16896
    s_waitcnt vmcnt(12)
    buffer_load_dwordx4 v28, s[24:27], s47 offen nt lds
    s_waitcnt vmcnt(12)
    buffer_load_dwordx4 v2, s[24:27], s47 offen offset:1056 nt lds
    s_cmp_eq_u32 s44, s45
    s_cselect_b32 s44, s50, s44
    s_lshl_b32 s73, s39, 12
    s_mov_b32 s70, 0
    s_mov_b32 s68, s44
    s_add_u32 s44, s44, 16896
    s_cmp_eq_u32 s44, s45
    s_cselect_b32 s44, s50, s44
    s_mov_b32 s69, s44
    s_add_u32 s44, s44, 16896
    s_cmp_eq_u32 s44, s45
    s_cselect_b32 s44, s50, s44
    s_waitcnt vmcnt(12)
    s_barrier
    s_add_u32 s46, s70, 0
    s_cmp_lt_u32 s46, s72
    s_cselect_b32 s48, s71, 0
    s_xor_b32 s46, s46, s48
    s_lshl_b32 s46, s46, 17
    s_add_u32 s46, s46, s73
    s_add_u32 s47, s70, 2
    s_cmp_lt_u32 s47, s72
    s_cselect_b32 s48, s71, 0
    s_xor_b32 s47, s47, s48
    s_lshl_b32 s47, s47, 17
    s_add_u32 s47, s47, s73
    s_add_u32 s70, s70, 1
    s_mov_b32 m0, s44
    s_add_u32 s48, s44, 8448
    buffer_load_dwordx4 v28, s[28:31], s46 offen nt lds
    s_waitcnt vmcnt(12)
    buffer_load_dwordx4 v2, s[28:31], s46 offen offset:1056 nt lds
    s_mov_b32 m0, s48
    s_add_u32 s44, s44, 16896
    s_waitcnt vmcnt(12)
    buffer_load_dwordx4 v28, s[24:27], s47 offen nt lds
    s_waitcnt vmcnt(12)
    buffer_load_dwordx4 v2, s[24:27], s47 offen offset:1056 nt lds
    s_cmp_eq_u32 s44, s45
    s_cselect_b32 s44, s50, s44
    s_add_u32 s46, s70, 0
    s_cmp_lt_u32 s46, s72
    s_cselect_b32 s48, s71, 0
    s_xor_b32 s46, s46, s48
    s_lshl_b32 s46, s46, 17
    s_add_u32 s46, s46, s73
    s_add_u32 s47, s70, 2
    s_cmp_lt_u32 s47, s72
    s_cselect_b32 s48, s71, 0
    s_xor_b32 s47, s47, s48
    s_lshl_b32 s47, s47, 17
    s_add_u32 s47, s47, s73
    s_add_u32 s70, s70, 1
    s_mov_b32 m0, s44
    s_add_u32 s48, s44, 8448
    s_waitcnt vmcnt(12)
    buffer_load_dwordx4 v28, s[28:31], s46 offen nt lds
    s_waitcnt vmcnt(12)
    buffer_load_dwordx4 v2, s[28:31], s46 offen offset:1056 nt lds
    s_mov_b32 m0, s48
    s_add_u32 s44, s44, 16896
    s_waitcnt vmcnt(12)
    buffer_load_dwordx4 v28, s[24:27], s47 offen nt lds
    s_waitcnt vmcnt(12)
    buffer_load_dwordx4 v2, s[24:27], s47 offen offset:1056 nt lds
    s_cmp_eq_u32 s44, s45
    s_cselect_b32 s44, s50, s44
    v_add_u32 v41, s68, v40
    v_lshlrev_b32 v44, 16, v64
    v_and_b32 v45, 0xffff0000, v64
    v_pk_mul_f32 v[44:45], v[44:45], v[52:53]
    v_cvt_pk_bf16_f32 v64, v44, v45
    v_lshlrev_b32 v46, 16, v65
    v_and_b32 v47, 0xffff0000, v65
    v_pk_mul_f32 v[46:47], v[46:47], v[52:53]
    v_cvt_pk_bf16_f32 v65, v46, v47
    v_lshlrev_b32 v48, 16, v66
    v_and_b32 v49, 0xffff0000, v66
    v_pk_mul_f32 v[48:49], v[48:49], v[52:53]
    v_cvt_pk_bf16_f32 v66, v48, v49
    v_lshlrev_b32 v50, 16, v67
    v_and_b32 v51, 0xffff0000, v67
    v_pk_mul_f32 v[50:51], v[50:51], v[52:53]
    v_cvt_pk_bf16_f32 v67, v50, v51
    ds_write_b128 v41, v[64:67] offset:0
    v_lshlrev_b32 v44, 16, v68
    v_and_b32 v45, 0xffff0000, v68
    v_pk_mul_f32 v[44:45], v[44:45], v[52:53]
    v_cvt_pk_bf16_f32 v68, v44, v45
    v_lshlrev_b32 v46, 16, v69
    v_and_b32 v47, 0xffff0000, v69
    v_pk_mul_f32 v[46:47], v[46:47], v[52:53]
    v_cvt_pk_bf16_f32 v69, v46, v47
    v_lshlrev_b32 v48, 16, v70
    v_and_b32 v49, 0xffff0000, v70
    v_pk_mul_f32 v[48:49], v[48:49], v[52:53]
    v_cvt_pk_bf16_f32 v70, v48, v49
    v_lshlrev_b32 v50, 16, v71
    v_and_b32 v51, 0xffff0000, v71
    v_pk_mul_f32 v[50:51], v[50:51], v[52:53]
    v_cvt_pk_bf16_f32 v71, v50, v51
    ds_write_b128 v41, v[68:71] offset:1056
    v_lshlrev_b32 v44, 16, v72
    v_and_b32 v45, 0xffff0000, v72
    v_pk_mul_f32 v[44:45], v[44:45], v[52:53]
    v_cvt_pk_bf16_f32 v72, v44, v45
    v_lshlrev_b32 v46, 16, v73
    v_and_b32 v47, 0xffff0000, v73
    v_pk_mul_f32 v[46:47], v[46:47], v[52:53]
    v_cvt_pk_bf16_f32 v73, v46, v47
    v_lshlrev_b32 v48, 16, v74
    v_and_b32 v49, 0xffff0000, v74
    v_pk_mul_f32 v[48:49], v[48:49], v[52:53]
    v_cvt_pk_bf16_f32 v74, v48, v49
    v_lshlrev_b32 v50, 16, v75
    v_and_b32 v51, 0xffff0000, v75
    v_pk_mul_f32 v[50:51], v[50:51], v[52:53]
    v_cvt_pk_bf16_f32 v75, v50, v51
    ds_write_b128 v41, v[72:75] offset:8448
    v_lshlrev_b32 v44, 16, v76
    v_and_b32 v45, 0xffff0000, v76
    v_pk_mul_f32 v[44:45], v[44:45], v[52:53]
    v_cvt_pk_bf16_f32 v76, v44, v45
    v_lshlrev_b32 v46, 16, v77
    v_and_b32 v47, 0xffff0000, v77
    v_pk_mul_f32 v[46:47], v[46:47], v[52:53]
    v_cvt_pk_bf16_f32 v77, v46, v47
    v_lshlrev_b32 v48, 16, v78
    v_and_b32 v49, 0xffff0000, v78
    v_pk_mul_f32 v[48:49], v[48:49], v[52:53]
    v_cvt_pk_bf16_f32 v78, v48, v49
    v_lshlrev_b32 v50, 16, v79
    v_and_b32 v51, 0xffff0000, v79
    v_pk_mul_f32 v[50:51], v[50:51], v[52:53]
    v_cvt_pk_bf16_f32 v79, v50, v51
    ds_write_b128 v41, v[76:79] offset:9504
    v_add_u32 v41, s69, v40
    s_waitcnt vmcnt(12)
    v_lshlrev_b32 v44, 16, v80
    v_and_b32 v45, 0xffff0000, v80
    v_pk_mul_f32 v[44:45], v[44:45], v[52:53]
    v_cvt_pk_bf16_f32 v80, v44, v45
    v_lshlrev_b32 v46, 16, v81
    v_and_b32 v47, 0xffff0000, v81
    v_pk_mul_f32 v[46:47], v[46:47], v[52:53]
    v_cvt_pk_bf16_f32 v81, v46, v47
    v_lshlrev_b32 v48, 16, v82
    v_and_b32 v49, 0xffff0000, v82
    v_pk_mul_f32 v[48:49], v[48:49], v[52:53]
    v_cvt_pk_bf16_f32 v82, v48, v49
    v_lshlrev_b32 v50, 16, v83
    v_and_b32 v51, 0xffff0000, v83
    v_pk_mul_f32 v[50:51], v[50:51], v[52:53]
    v_cvt_pk_bf16_f32 v83, v50, v51
    ds_write_b128 v41, v[80:83] offset:0
    v_lshlrev_b32 v44, 16, v84
    v_and_b32 v45, 0xffff0000, v84
    v_pk_mul_f32 v[44:45], v[44:45], v[52:53]
    v_cvt_pk_bf16_f32 v84, v44, v45
    v_lshlrev_b32 v46, 16, v85
    v_and_b32 v47, 0xffff0000, v85
    v_pk_mul_f32 v[46:47], v[46:47], v[52:53]
    v_cvt_pk_bf16_f32 v85, v46, v47
    v_lshlrev_b32 v48, 16, v86
    v_and_b32 v49, 0xffff0000, v86
    v_pk_mul_f32 v[48:49], v[48:49], v[52:53]
    v_cvt_pk_bf16_f32 v86, v48, v49
    v_lshlrev_b32 v50, 16, v87
    v_and_b32 v51, 0xffff0000, v87
    v_pk_mul_f32 v[50:51], v[50:51], v[52:53]
    v_cvt_pk_bf16_f32 v87, v50, v51
    ds_write_b128 v41, v[84:87] offset:1056
    v_lshlrev_b32 v44, 16, v88
    v_and_b32 v45, 0xffff0000, v88
    v_pk_mul_f32 v[44:45], v[44:45], v[52:53]
    v_cvt_pk_bf16_f32 v88, v44, v45
    v_lshlrev_b32 v46, 16, v89
    v_and_b32 v47, 0xffff0000, v89
    v_pk_mul_f32 v[46:47], v[46:47], v[52:53]
    v_cvt_pk_bf16_f32 v89, v46, v47
    v_lshlrev_b32 v48, 16, v90
    v_and_b32 v49, 0xffff0000, v90
    v_pk_mul_f32 v[48:49], v[48:49], v[52:53]
    v_cvt_pk_bf16_f32 v90, v48, v49
    v_lshlrev_b32 v50, 16, v91
    v_and_b32 v51, 0xffff0000, v91
    v_pk_mul_f32 v[50:51], v[50:51], v[52:53]
    v_cvt_pk_bf16_f32 v91, v50, v51
    ds_write_b128 v41, v[88:91] offset:8448
    v_lshlrev_b32 v44, 16, v92
    v_and_b32 v45, 0xffff0000, v92
    v_pk_mul_f32 v[44:45], v[44:45], v[52:53]
    v_cvt_pk_bf16_f32 v92, v44, v45
    v_lshlrev_b32 v46, 16, v93
    v_and_b32 v47, 0xffff0000, v93
    v_pk_mul_f32 v[46:47], v[46:47], v[52:53]
    v_cvt_pk_bf16_f32 v93, v46, v47
    v_lshlrev_b32 v48, 16, v94
    v_and_b32 v49, 0xffff0000, v94
    v_pk_mul_f32 v[48:49], v[48:49], v[52:53]
    v_cvt_pk_bf16_f32 v94, v48, v49
    v_lshlrev_b32 v50, 16, v95
    v_and_b32 v51, 0xffff0000, v95
    v_pk_mul_f32 v[50:51], v[50:51], v[52:53]
    v_cvt_pk_bf16_f32 v95, v50, v51
    ds_write_b128 v41, v[92:95] offset:9504
    s_waitcnt vmcnt(8)
    s_waitcnt lgkmcnt(0)
    s_barrier
    s_add_u32 s46, s70, 0
    s_cmp_lt_u32 s46, s72
    s_cselect_b32 s48, s71, 0
    s_xor_b32 s46, s46, s48
    s_lshl_b32 s46, s46, 17
    s_add_u32 s46, s46, s73
    s_add_u32 s47, s70, 2
    s_cmp_lt_u32 s47, s72
    s_cselect_b32 s48, s71, 0
    s_xor_b32 s47, s47, s48
    s_lshl_b32 s47, s47, 17
    s_add_u32 s47, s47, s73
    s_add_u32 s70, s70, 1
    s_mov_b32 m0, s44
    s_add_u32 s48, s44, 8448
    buffer_load_dwordx4 v28, s[28:31], s46 offen nt lds
    buffer_load_dwordx4 v2, s[28:31], s46 offen offset:1056 nt lds
    s_mov_b32 m0, s48
    s_add_u32 s44, s44, 16896
    buffer_load_dwordx4 v28, s[24:27], s47 offen nt lds
    buffer_load_dwordx4 v2, s[24:27], s47 offen offset:1056 nt lds
    s_cmp_eq_u32 s44, s45
    s_cselect_b32 s44, s50, s44
    s_add_u32 s46, s70, 0
    s_cmp_lt_u32 s46, s72
    s_cselect_b32 s48, s71, 0
    s_xor_b32 s46, s46, s48
    s_lshl_b32 s46, s46, 17
    s_add_u32 s46, s46, s73
    s_add_u32 s47, s70, 2
    s_cmp_lt_u32 s47, s72
    s_cselect_b32 s48, s71, 0
    s_xor_b32 s47, s47, s48
    s_lshl_b32 s47, s47, 17
    s_add_u32 s47, s47, s73
    s_add_u32 s70, s70, 1
    s_mov_b32 m0, s44
    s_add_u32 s48, s44, 8448
    buffer_load_dwordx4 v28, s[28:31], s46 offen nt lds
    s_waitcnt vmcnt(12)
    buffer_load_dwordx4 v2, s[28:31], s46 offen offset:1056 nt lds
    s_mov_b32 m0, s48
    s_add_u32 s44, s44, 16896
    s_waitcnt vmcnt(12)
    buffer_load_dwordx4 v28, s[24:27], s47 offen nt lds
    s_waitcnt vmcnt(12)
    buffer_load_dwordx4 v2, s[24:27], s47 offen offset:1056 nt lds
    s_cmp_eq_u32 s44, s45
    s_cselect_b32 s44, s50, s44
    s_branch L_pdk
L_pdk:
    s_waitcnt vmcnt(12)
    s_barrier
    s_waitcnt vmcnt(8)
    s_barrier
    s_waitcnt vmcnt(4)
    s_barrier
    s_waitcnt vmcnt(0)
    s_barrier
    s_endpgm
L_pdual:
    s_mov_b32 s44, s50
    s_add_u32 s45, s50, 67584
    s_mov_b32 m0, s44
    s_add_u32 s48, s44, 8448
    buffer_load_dwordx4 v28, s[24:27], s46 offen nt lds
    buffer_load_dwordx4 v2, s[24:27], s46 offen offset:1056 nt lds
    s_mov_b32 m0, s48
    s_add_u32 s48, s44, 67584
    buffer_load_dwordx4 v28, s[24:27], s47 offen nt lds
    buffer_load_dwordx4 v2, s[24:27], s47 offen offset:1056 nt lds
    s_mov_b32 m0, s48
    s_add_u32 s51, s46, 256
    s_add_u32 s48, s44, 76032
    buffer_load_dwordx4 v28, s[24:27], s51 offen nt lds
    buffer_load_dwordx4 v2, s[24:27], s51 offen offset:1056 nt lds
    s_mov_b32 m0, s48
    s_add_u32 s57, s47, 256
    s_add_u32 s44, s44, 16896
    buffer_load_dwordx4 v28, s[24:27], s57 offen nt lds
    buffer_load_dwordx4 v2, s[24:27], s57 offen offset:1056 nt lds
    s_cmp_eq_u32 s44, s45
    s_cselect_b32 s44, s50, s44
    s_mov_b32 s68, s44
    s_add_u32 s44, s44, 16896
    s_mov_b32 s19, s88
    s_add_u32 s28, s8, s19
    s_addc_u32 s29, s9, 0
    s_mov_b32 s31, 0x20000
    s_mov_b32 s30, s87
    s_add_u32 s47, s46, 262144
    s_and_b32 s42, s89, 255
    s_mov_b32 s37, s91
    v_lshlrev_b32 v40, 4, v0
    s_mov_b32 s59, 0x3e0293ee
    v_mov_b32 v52, s59
    v_mov_b32 v53, s59
    v_add_u32 v41, s68, v40
    s_waitcnt vmcnt(11)
    v_lshlrev_b32 v44, 16, v112
    v_and_b32 v45, 0xffff0000, v112
    v_pk_mul_f32 v[44:45], v[44:45], v[52:53]
    v_cvt_pk_bf16_f32 v112, v44, v45
    v_lshlrev_b32 v46, 16, v113
    v_and_b32 v47, 0xffff0000, v113
    v_pk_mul_f32 v[46:47], v[46:47], v[52:53]
    v_cvt_pk_bf16_f32 v113, v46, v47
    v_lshlrev_b32 v48, 16, v114
    v_and_b32 v49, 0xffff0000, v114
    v_pk_mul_f32 v[48:49], v[48:49], v[52:53]
    v_cvt_pk_bf16_f32 v114, v48, v49
    v_lshlrev_b32 v50, 16, v115
    v_and_b32 v51, 0xffff0000, v115
    v_pk_mul_f32 v[50:51], v[50:51], v[52:53]
    v_cvt_pk_bf16_f32 v115, v50, v51
    ds_write_b128 v41, v[112:115] offset:0
    s_waitcnt vmcnt(10)
    v_lshlrev_b32 v44, 16, v116
    v_and_b32 v45, 0xffff0000, v116
    v_pk_mul_f32 v[44:45], v[44:45], v[52:53]
    v_cvt_pk_bf16_f32 v116, v44, v45
    v_lshlrev_b32 v46, 16, v117
    v_and_b32 v47, 0xffff0000, v117
    v_pk_mul_f32 v[46:47], v[46:47], v[52:53]
    v_cvt_pk_bf16_f32 v117, v46, v47
    v_lshlrev_b32 v48, 16, v118
    v_and_b32 v49, 0xffff0000, v118
    v_pk_mul_f32 v[48:49], v[48:49], v[52:53]
    v_cvt_pk_bf16_f32 v118, v48, v49
    v_lshlrev_b32 v50, 16, v119
    v_and_b32 v51, 0xffff0000, v119
    v_pk_mul_f32 v[50:51], v[50:51], v[52:53]
    v_cvt_pk_bf16_f32 v119, v50, v51
    ds_write_b128 v41, v[116:119] offset:1056
    s_mov_b32 m0, s44
    s_add_u32 s48, s44, 8448
    buffer_load_dwordx4 v28, s[28:31], s46 offen nt lds
    buffer_load_dwordx4 v2, s[28:31], s46 offen offset:1056 nt lds
    s_mov_b32 m0, s48
    s_add_u32 s48, s44, 67584
    buffer_load_dwordx4 v28, s[24:27], s47 offen nt lds
    s_waitcnt vmcnt(12)
    buffer_load_dwordx4 v2, s[24:27], s47 offen offset:1056 nt lds
    s_mov_b32 m0, s48
    s_add_u32 s51, s46, 256
    s_add_u32 s48, s44, 76032
    s_waitcnt vmcnt(12)
    buffer_load_dwordx4 v28, s[28:31], s51 offen nt lds
    s_waitcnt vmcnt(12)
    buffer_load_dwordx4 v2, s[28:31], s51 offen offset:1056 nt lds
    s_mov_b32 m0, s48
    s_add_u32 s57, s47, 256
    s_add_u32 s44, s44, 16896
    s_waitcnt vmcnt(12)
    buffer_load_dwordx4 v28, s[24:27], s57 offen nt lds
    s_waitcnt vmcnt(12)
    buffer_load_dwordx4 v2, s[24:27], s57 offen offset:1056 nt lds
    s_cmp_eq_u32 s44, s45
    s_cselect_b32 s44, s50, s44
    s_add_u32 s46, s46, 131072
    s_add_u32 s47, s47, 131072
    v_lshlrev_b32 v44, 16, v120
    v_and_b32 v45, 0xffff0000, v120
    v_pk_mul_f32 v[44:45], v[44:45], v[52:53]
    v_cvt_pk_bf16_f32 v120, v44, v45
    v_lshlrev_b32 v46, 16, v121
    v_and_b32 v47, 0xffff0000, v121
    v_pk_mul_f32 v[46:47], v[46:47], v[52:53]
    v_cvt_pk_bf16_f32 v121, v46, v47
    v_lshlrev_b32 v48, 16, v122
    v_and_b32 v49, 0xffff0000, v122
    v_pk_mul_f32 v[48:49], v[48:49], v[52:53]
    v_cvt_pk_bf16_f32 v122, v48, v49
    v_lshlrev_b32 v50, 16, v123
    v_and_b32 v51, 0xffff0000, v123
    v_pk_mul_f32 v[50:51], v[50:51], v[52:53]
    v_cvt_pk_bf16_f32 v123, v50, v51
    ds_write_b128 v41, v[120:123] offset:8448
    v_lshlrev_b32 v44, 16, v124
    v_and_b32 v45, 0xffff0000, v124
    v_pk_mul_f32 v[44:45], v[44:45], v[52:53]
    v_cvt_pk_bf16_f32 v124, v44, v45
    v_lshlrev_b32 v46, 16, v125
    v_and_b32 v47, 0xffff0000, v125
    v_pk_mul_f32 v[46:47], v[46:47], v[52:53]
    v_cvt_pk_bf16_f32 v125, v46, v47
    v_lshlrev_b32 v48, 16, v126
    v_and_b32 v49, 0xffff0000, v126
    v_pk_mul_f32 v[48:49], v[48:49], v[52:53]
    v_cvt_pk_bf16_f32 v126, v48, v49
    v_lshlrev_b32 v50, 16, v127
    v_and_b32 v51, 0xffff0000, v127
    v_pk_mul_f32 v[50:51], v[50:51], v[52:53]
    v_cvt_pk_bf16_f32 v127, v50, v51
    ds_write_b128 v41, v[124:127] offset:9504
    s_waitcnt vmcnt(8)
    s_waitcnt lgkmcnt(0)
    s_barrier
    s_mov_b32 m0, s44
    s_add_u32 s48, s44, 8448
    buffer_load_dwordx4 v28, s[28:31], s46 offen nt lds
    buffer_load_dwordx4 v2, s[28:31], s46 offen offset:1056 nt lds
    s_mov_b32 m0, s48
    s_add_u32 s48, s44, 67584
    buffer_load_dwordx4 v28, s[24:27], s47 offen nt lds
    buffer_load_dwordx4 v2, s[24:27], s47 offen offset:1056 nt lds
    s_mov_b32 m0, s48
    s_add_u32 s51, s46, 256
    s_add_u32 s48, s44, 76032
    buffer_load_dwordx4 v28, s[28:31], s51 offen nt lds
    s_waitcnt vmcnt(12)
    buffer_load_dwordx4 v2, s[28:31], s51 offen offset:1056 nt lds
    s_mov_b32 m0, s48
    s_add_u32 s57, s47, 256
    s_add_u32 s44, s44, 16896
    s_waitcnt vmcnt(12)
    buffer_load_dwordx4 v28, s[24:27], s57 offen nt lds
    s_waitcnt vmcnt(12)
    buffer_load_dwordx4 v2, s[24:27], s57 offen offset:1056 nt lds
    s_cmp_eq_u32 s44, s45
    s_cselect_b32 s44, s50, s44
    s_add_u32 s46, s46, 131072
    s_add_u32 s47, s47, 131072
    s_setprio 0
    s_sub_u32 s49, s42, 2
L_ptd:
    s_cmp_eq_u32 s49, 0
    s_cbranch_scc1 L_ped
    s_waitcnt vmcnt(8)
    s_barrier
    s_mov_b32 m0, s44
    s_add_u32 s48, s44, 8448
    buffer_load_dwordx4 v28, s[28:31], s46 offen nt lds
    buffer_load_dwordx4 v2, s[28:31], s46 offen offset:1056 nt lds
    s_mov_b32 m0, s48
    s_add_u32 s48, s44, 67584
    buffer_load_dwordx4 v28, s[24:27], s47 offen nt lds
    buffer_load_dwordx4 v2, s[24:27], s47 offen offset:1056 nt lds
    s_mov_b32 m0, s48
    s_add_u32 s51, s46, 256
    s_add_u32 s48, s44, 76032
    buffer_load_dwordx4 v28, s[28:31], s51 offen nt lds
    s_waitcnt vmcnt(12)
    buffer_load_dwordx4 v2, s[28:31], s51 offen offset:1056 nt lds
    s_mov_b32 m0, s48
    s_add_u32 s57, s47, 256
    s_add_u32 s44, s44, 16896
    s_waitcnt vmcnt(12)
    buffer_load_dwordx4 v28, s[24:27], s57 offen nt lds
    s_waitcnt vmcnt(12)
    buffer_load_dwordx4 v2, s[24:27], s57 offen offset:1056 nt lds
    s_cmp_eq_u32 s44, s45
    s_cselect_b32 s44, s50, s44
    s_add_u32 s46, s46, 131072
    s_add_u32 s47, s47, 131072
    s_sub_u32 s49, s49, 1
    s_branch L_ptd
L_ped:
    s_cmp_eq_u32 s37, 0
    s_cbranch_scc1 L_pdd
    s_waitcnt vmcnt(8)
    s_barrier
    s_mov_b32 s36, s37
    s_mov_b32 s37, 0
    s_and_b32 s39, s36, 0xfff
    s_bfe_u32 s40, s36, 0x9000c
    s_bfe_u32 s41, s36, 0x20015
    s_lshl_b32 s41, s41, 7
    s_add_u32 s41, s41, s39
    s_add_u32 s42, s40, 31
    s_lshr_b32 s42, s42, 5
    s_add_u32 s43, s39, s40
    s_lshl_b32 s43, s43, 12
    s_sub_u32 s43, s43, 3584
    s_mov_b32 s22, s43
    s_lshl_b32 s74, s41, 12
    s_add_u32 s75, s74, 131072
    s_add_u32 s76, s74, 256
    s_add_u32 s77, s74, 131328
    buffer_load_dwordx4 v[64:67], v28, s[20:23], s74 offen nt
    buffer_load_dwordx4 v[68:71], v29, s[20:23], s74 offen nt
    buffer_load_dwordx4 v[72:75], v28, s[20:23], s75 offen nt
    buffer_load_dwordx4 v[76:79], v29, s[20:23], s75 offen nt
    buffer_load_dwordx4 v[80:83], v28, s[20:23], s76 offen nt
    s_waitcnt vmcnt(12)
    buffer_load_dwordx4 v[84:87], v29, s[20:23], s76 offen nt
    s_waitcnt vmcnt(12)
    buffer_load_dwordx4 v[88:91], v28, s[20:23], s77 offen nt
    s_waitcnt vmcnt(12)
    buffer_load_dwordx4 v[92:95], v29, s[20:23], s77 offen nt
    s_waitcnt vmcnt(8)
    s_barrier
    s_mov_b32 s26, s43
    s_mov_b32 s30, s43
    s_lshl_b32 s46, s39, 12
    s_add_u32 s47, s46, 131072
    s_add_u32 s44, s44, 16896
    s_cmp_eq_u32 s44, s45
    s_cselect_b32 s44, s50, s44
    s_mov_b32 m0, s44
    s_add_u32 s48, s44, 8448
    buffer_load_dwordx4 v28, s[24:27], s46 offen nt lds
    buffer_load_dwordx4 v2, s[24:27], s46 offen offset:1056 nt lds
    s_mov_b32 m0, s48
    s_add_u32 s48, s44, 67584
    buffer_load_dwordx4 v28, s[24:27], s47 offen nt lds
    buffer_load_dwordx4 v2, s[24:27], s47 offen offset:1056 nt lds
    s_mov_b32 m0, s48
    s_add_u32 s51, s46, 256
    s_add_u32 s48, s44, 76032
    buffer_load_dwordx4 v28, s[24:27], s51 offen nt lds
    s_waitcnt vmcnt(12)
    buffer_load_dwordx4 v2, s[24:27], s51 offen offset:1056 nt lds
    s_mov_b32 m0, s48
    s_add_u32 s57, s47, 256
    s_add_u32 s44, s44, 16896
    s_waitcnt vmcnt(12)
    buffer_load_dwordx4 v28, s[24:27], s57 offen nt lds
    s_waitcnt vmcnt(12)
    buffer_load_dwordx4 v2, s[24:27], s57 offen offset:1056 nt lds
    s_cmp_eq_u32 s44, s45
    s_cselect_b32 s44, s50, s44
    s_lshl_b32 s46, s39, 12
    s_add_u32 s47, s46, 262144
    s_mov_b32 s68, s44
    s_add_u32 s44, s44, 16896
    s_cmp_eq_u32 s44, s45
    s_cselect_b32 s44, s50, s44
    v_add_u32 v41, s68, v40
    v_add_u32 v42, 67584, v41
    s_waitcnt vmcnt(12)
    v_lshlrev_b32 v44, 16, v64
    v_and_b32 v45, 0xffff0000, v64
    v_pk_mul_f32 v[44:45], v[44:45], v[52:53]
    v_cvt_pk_bf16_f32 v64, v44, v45
    v_lshlrev_b32 v46, 16, v65
    v_and_b32 v47, 0xffff0000, v65
    v_pk_mul_f32 v[46:47], v[46:47], v[52:53]
    v_cvt_pk_bf16_f32 v65, v46, v47
    v_lshlrev_b32 v48, 16, v66
    v_and_b32 v49, 0xffff0000, v66
    v_pk_mul_f32 v[48:49], v[48:49], v[52:53]
    v_cvt_pk_bf16_f32 v66, v48, v49
    v_lshlrev_b32 v50, 16, v67
    v_and_b32 v51, 0xffff0000, v67
    v_pk_mul_f32 v[50:51], v[50:51], v[52:53]
    v_cvt_pk_bf16_f32 v67, v50, v51
    ds_write_b128 v41, v[64:67] offset:0
    s_waitcnt vmcnt(11)
    v_lshlrev_b32 v44, 16, v68
    v_and_b32 v45, 0xffff0000, v68
    v_pk_mul_f32 v[44:45], v[44:45], v[52:53]
    v_cvt_pk_bf16_f32 v68, v44, v45
    v_lshlrev_b32 v46, 16, v69
    v_and_b32 v47, 0xffff0000, v69
    v_pk_mul_f32 v[46:47], v[46:47], v[52:53]
    v_cvt_pk_bf16_f32 v69, v46, v47
    v_lshlrev_b32 v48, 16, v70
    v_and_b32 v49, 0xffff0000, v70
    v_pk_mul_f32 v[48:49], v[48:49], v[52:53]
    v_cvt_pk_bf16_f32 v70, v48, v49
    v_lshlrev_b32 v50, 16, v71
    v_and_b32 v51, 0xffff0000, v71
    v_pk_mul_f32 v[50:51], v[50:51], v[52:53]
    v_cvt_pk_bf16_f32 v71, v50, v51
    ds_write_b128 v41, v[68:71] offset:1056
    s_waitcnt vmcnt(10)
    v_lshlrev_b32 v44, 16, v72
    v_and_b32 v45, 0xffff0000, v72
    v_pk_mul_f32 v[44:45], v[44:45], v[52:53]
    v_cvt_pk_bf16_f32 v72, v44, v45
    v_lshlrev_b32 v46, 16, v73
    v_and_b32 v47, 0xffff0000, v73
    v_pk_mul_f32 v[46:47], v[46:47], v[52:53]
    v_cvt_pk_bf16_f32 v73, v46, v47
    v_lshlrev_b32 v48, 16, v74
    v_and_b32 v49, 0xffff0000, v74
    v_pk_mul_f32 v[48:49], v[48:49], v[52:53]
    v_cvt_pk_bf16_f32 v74, v48, v49
    v_lshlrev_b32 v50, 16, v75
    v_and_b32 v51, 0xffff0000, v75
    v_pk_mul_f32 v[50:51], v[50:51], v[52:53]
    v_cvt_pk_bf16_f32 v75, v50, v51
    ds_write_b128 v41, v[72:75] offset:8448
    s_waitcnt vmcnt(9)
    v_lshlrev_b32 v44, 16, v76
    v_and_b32 v45, 0xffff0000, v76
    v_pk_mul_f32 v[44:45], v[44:45], v[52:53]
    v_cvt_pk_bf16_f32 v76, v44, v45
    v_lshlrev_b32 v46, 16, v77
    v_and_b32 v47, 0xffff0000, v77
    v_pk_mul_f32 v[46:47], v[46:47], v[52:53]
    v_cvt_pk_bf16_f32 v77, v46, v47
    v_lshlrev_b32 v48, 16, v78
    v_and_b32 v49, 0xffff0000, v78
    v_pk_mul_f32 v[48:49], v[48:49], v[52:53]
    v_cvt_pk_bf16_f32 v78, v48, v49
    v_lshlrev_b32 v50, 16, v79
    v_and_b32 v51, 0xffff0000, v79
    v_pk_mul_f32 v[50:51], v[50:51], v[52:53]
    v_cvt_pk_bf16_f32 v79, v50, v51
    ds_write_b128 v41, v[76:79] offset:9504
    s_waitcnt vmcnt(8)
    v_lshlrev_b32 v44, 16, v80
    v_and_b32 v45, 0xffff0000, v80
    v_pk_mul_f32 v[44:45], v[44:45], v[52:53]
    v_cvt_pk_bf16_f32 v80, v44, v45
    v_lshlrev_b32 v46, 16, v81
    v_and_b32 v47, 0xffff0000, v81
    v_pk_mul_f32 v[46:47], v[46:47], v[52:53]
    v_cvt_pk_bf16_f32 v81, v46, v47
    v_lshlrev_b32 v48, 16, v82
    v_and_b32 v49, 0xffff0000, v82
    v_pk_mul_f32 v[48:49], v[48:49], v[52:53]
    v_cvt_pk_bf16_f32 v82, v48, v49
    v_lshlrev_b32 v50, 16, v83
    v_and_b32 v51, 0xffff0000, v83
    v_pk_mul_f32 v[50:51], v[50:51], v[52:53]
    v_cvt_pk_bf16_f32 v83, v50, v51
    ds_write_b128 v42, v[80:83] offset:0
    v_lshlrev_b32 v44, 16, v84
    v_and_b32 v45, 0xffff0000, v84
    v_pk_mul_f32 v[44:45], v[44:45], v[52:53]
    v_cvt_pk_bf16_f32 v84, v44, v45
    v_lshlrev_b32 v46, 16, v85
    v_and_b32 v47, 0xffff0000, v85
    v_pk_mul_f32 v[46:47], v[46:47], v[52:53]
    v_cvt_pk_bf16_f32 v85, v46, v47
    v_lshlrev_b32 v48, 16, v86
    v_and_b32 v49, 0xffff0000, v86
    v_pk_mul_f32 v[48:49], v[48:49], v[52:53]
    v_cvt_pk_bf16_f32 v86, v48, v49
    v_lshlrev_b32 v50, 16, v87
    v_and_b32 v51, 0xffff0000, v87
    v_pk_mul_f32 v[50:51], v[50:51], v[52:53]
    v_cvt_pk_bf16_f32 v87, v50, v51
    ds_write_b128 v42, v[84:87] offset:1056
    v_lshlrev_b32 v44, 16, v88
    v_and_b32 v45, 0xffff0000, v88
    v_pk_mul_f32 v[44:45], v[44:45], v[52:53]
    v_cvt_pk_bf16_f32 v88, v44, v45
    v_lshlrev_b32 v46, 16, v89
    v_and_b32 v47, 0xffff0000, v89
    v_pk_mul_f32 v[46:47], v[46:47], v[52:53]
    v_cvt_pk_bf16_f32 v89, v46, v47
    v_lshlrev_b32 v48, 16, v90
    v_and_b32 v49, 0xffff0000, v90
    v_pk_mul_f32 v[48:49], v[48:49], v[52:53]
    v_cvt_pk_bf16_f32 v90, v48, v49
    v_lshlrev_b32 v50, 16, v91
    v_and_b32 v51, 0xffff0000, v91
    v_pk_mul_f32 v[50:51], v[50:51], v[52:53]
    v_cvt_pk_bf16_f32 v91, v50, v51
    ds_write_b128 v42, v[88:91] offset:8448
    v_lshlrev_b32 v44, 16, v92
    v_and_b32 v45, 0xffff0000, v92
    v_pk_mul_f32 v[44:45], v[44:45], v[52:53]
    v_cvt_pk_bf16_f32 v92, v44, v45
    v_lshlrev_b32 v46, 16, v93
    v_and_b32 v47, 0xffff0000, v93
    v_pk_mul_f32 v[46:47], v[46:47], v[52:53]
    v_cvt_pk_bf16_f32 v93, v46, v47
    v_lshlrev_b32 v48, 16, v94
    v_and_b32 v49, 0xffff0000, v94
    v_pk_mul_f32 v[48:49], v[48:49], v[52:53]
    v_cvt_pk_bf16_f32 v94, v48, v49
    v_lshlrev_b32 v50, 16, v95
    v_and_b32 v51, 0xffff0000, v95
    v_pk_mul_f32 v[50:51], v[50:51], v[52:53]
    v_cvt_pk_bf16_f32 v95, v50, v51
    ds_write_b128 v42, v[92:95] offset:9504
    s_waitcnt vmcnt(0)
    s_waitcnt lgkmcnt(0)
    s_barrier
    s_mov_b32 m0, s44
    s_add_u32 s48, s44, 8448
    buffer_load_dwordx4 v28, s[28:31], s46 offen nt lds
    buffer_load_dwordx4 v2, s[28:31], s46 offen offset:1056 nt lds
    s_mov_b32 m0, s48
    s_add_u32 s48, s44, 67584
    buffer_load_dwordx4 v28, s[24:27], s47 offen nt lds
    buffer_load_dwordx4 v2, s[24:27], s47 offen offset:1056 nt lds
    s_mov_b32 m0, s48
    s_add_u32 s51, s46, 256
    s_add_u32 s48, s44, 76032
    buffer_load_dwordx4 v28, s[28:31], s51 offen nt lds
    buffer_load_dwordx4 v2, s[28:31], s51 offen offset:1056 nt lds
    s_mov_b32 m0, s48
    s_add_u32 s57, s47, 256
    s_add_u32 s44, s44, 16896
    buffer_load_dwordx4 v28, s[24:27], s57 offen nt lds
    buffer_load_dwordx4 v2, s[24:27], s57 offen offset:1056 nt lds
    s_cmp_eq_u32 s44, s45
    s_cselect_b32 s44, s50, s44
    s_add_u32 s46, s46, 131072
    s_add_u32 s47, s47, 131072
    s_mov_b32 m0, s44
    s_add_u32 s48, s44, 8448
    buffer_load_dwordx4 v28, s[28:31], s46 offen nt lds
    buffer_load_dwordx4 v2, s[28:31], s46 offen offset:1056 nt lds
    s_mov_b32 m0, s48
    s_add_u32 s48, s44, 67584
    buffer_load_dwordx4 v28, s[24:27], s47 offen nt lds
    buffer_load_dwordx4 v2, s[24:27], s47 offen offset:1056 nt lds
    s_mov_b32 m0, s48
    s_add_u32 s51, s46, 256
    s_add_u32 s48, s44, 76032
    buffer_load_dwordx4 v28, s[28:31], s51 offen nt lds
    s_waitcnt vmcnt(12)
    buffer_load_dwordx4 v2, s[28:31], s51 offen offset:1056 nt lds
    s_mov_b32 m0, s48
    s_add_u32 s57, s47, 256
    s_add_u32 s44, s44, 16896
    s_waitcnt vmcnt(12)
    buffer_load_dwordx4 v28, s[24:27], s57 offen nt lds
    s_waitcnt vmcnt(12)
    buffer_load_dwordx4 v2, s[24:27], s57 offen offset:1056 nt lds
    s_cmp_eq_u32 s44, s45
    s_cselect_b32 s44, s50, s44
    s_add_u32 s46, s46, 131072
    s_add_u32 s47, s47, 131072
    s_sub_u32 s49, s42, 2
    s_branch L_ptd
L_pdd:
    s_waitcnt vmcnt(8)
    s_barrier
    s_waitcnt vmcnt(0)
    s_barrier
    s_endpgm
.p2align 6
L_cons:
    s_setprio 1
    s_mov_b32 s36, s90
    s_mov_b32 s37, s91
    s_mov_b32 s19, s88
    s_bfe_u32 s38, s89, 0x10008
    s_mov_b32 s100, s38
    s_and_b32 s39, s36, 0xfff
    s_bfe_u32 s40, s36, 0x9000c
    s_bfe_u32 s41, s36, 0x20015
    s_lshl_b32 s41, s41, 7
    s_add_u32 s41, s41, s39
    s_add_u32 s42, s40, 31
    s_lshr_b32 s42, s42, 5
    s_add_u32 s43, s39, s40
    s_lshl_b32 s43, s43, 12
    s_sub_u32 s43, s43, 3584
    v_lshrrev_b32 v32, 4, v0
    v_bfe_u32 v33, v0, 3, 1
    v_lshl_add_u32 v34, v33, 2, v0
    v_and_b32 v34, 7, v34
    v_mul_u32_u24 v34, 1056, v34
    v_lshl_add_u32 v34, v33, 8, v34
    v_xor_b32 v33, v33, v32
    v_lshl_add_u32 v3, v33, 4, v34
    v_lshrrev_b32 v33, 5, v0
    v_lshrrev_b32 v34, 2, v0
    v_lshl_add_u32 v34, v33, 2, v34
    v_and_b32 v34, 7, v34
    v_mul_u32_u24 v34, 1056, v34
    v_lshl_add_u32 v34, v33, 8, v34
    v_and_b32 v35, 3, v0
    v_lshlrev_b32 v35, 3, v35
    v_lshlrev_b32 v36, 4, v33
    v_xor_b32 v35, v35, v36
    v_add_u32 v4, v34, v35
    v_xor_b32 v34, v32, v33
    v_and_b32 v34, 1, v34
    v_lshl_add_u32 v19, v34, 4, v33
    s_lshr_b32 s48, s18, 1
    s_mul_i32 s48, s48, s38
    s_mul_i32 s49, s48, 67584
    s_lshl_b32 s48, s48, 8
    s_add_u32 s19, s19, s48
    s_cmp_eq_u32 s38, 0
    s_cselect_b32 s51, 3, 1
    s_and_b32 s57, s18, s51
    v_add_u32 v3, s49, v3
    v_add_u32 v4, s49, v4
    s_mul_i32 s48, s18, 4352
    s_add_u32 s48, s48, 135168
    v_and_b32 v34, 15, v0
    v_mul_u32_u24 v35, 272, v34
    v_lshl_add_u32 v35, v32, 3, v35
    v_add_u32 v9, s48, v35
    v_lshlrev_b32 v34, 4, v34
    v_mul_u32_u24 v36, 272, v32
    v_add3_u32 v11, v36, v34, s48
    v_lshl_add_u32 v7, v32, 14, v34
    v_add_u32 v8, 8192, v7
    v_and_b32 v34, 3, v0
    v_cmp_eq_u32 vcc, 0, v34
    v_mov_b32 v35, 0x3f803f80
    s_nop 0
    v_cndmask_b32 v152, 0, v35, vcc
    v_cndmask_b32 v153, 0, v35, vcc
    v_cndmask_b32 v154, 0, v35, vcc
    v_cndmask_b32 v155, 0, v35, vcc
    s_mov_b32 s44, 0
    s_mov_b32 s50, 0x3e0293ee
    s_mov_b32 s58, 0
    s_mov_b32 s59, 1
    s_mov_b32 s96, s36
    s_mov_b32 s97, s37
    s_mov_b32 s98, 0x5d800000
    s_mov_b32 s99, 0x21800000
    s_cmp_eq_u32 s38, 0
    s_mov_b32 s49, 84480
    s_cselect_b32 s49, 50688, s49
    s_mul_i32 s48, s18, 2112
    s_add_u32 s49, s49, s48
    v_lshlrev_b32 v80, 4, v0
    v_add_u32 v80, s49, v80
    s_add_u32 s32, s12, s19
    s_addc_u32 s33, s13, 0
    s_mov_b32 s35, 0x20000
    s_mov_b32 s34, s43
    s_lshl_b32 s48, s57, 5
    s_add_u32 s48, s48, s41
    s_lshl_b32 s60, s48, 12
    s_add_u32 s61, s60, 65536
    s_add_u32 s62, s60, 69632
    s_add_u32 s63, s60, 4096
    s_sub_u32 s48, s42, 1
    s_lshl_b32 s48, s48, 5
    s_sub_u32 s48, s40, s48
    v_sub_u32 v6, s48, v19
    v_cmp_lt_i32 s[64:65], 0, v6
    v_cmp_lt_i32 s[66:67], 4, v6
    v_cmp_lt_i32 s[68:69], 8, v6
    v_cmp_lt_i32 s[70:71], 12, v6
    v_cmp_lt_i32 s[72:73], 2, v6
    v_cmp_lt_i32 s[74:75], 6, v6
    v_cmp_lt_i32 s[76:77], 10, v6
    v_cmp_lt_i32 s[78:79], 14, v6
    v_and_b32 v12, 0xffff, v152
    v_mov_b64 v[144:145], 0
    v_mov_b64 v[146:147], 0
    v_mov_b64 v[148:149], 0
    v_mov_b64 v[150:151], 0
    v_cndmask_b32 v156, 0, v12, s[64:65]
    v_cndmask_b32 v157, 0, v12, s[68:69]
    v_cndmask_b32 v158, 0, v12, s[72:73]
    v_cndmask_b32 v159, 0, v12, s[76:77]
    v_cndmask_b32 v156, v156, v152, s[66:67]
    v_cndmask_b32 v157, v157, v152, s[70:71]
    v_cndmask_b32 v158, v158, v152, s[74:75]
    v_cndmask_b32 v159, v159, v152, s[78:79]
    v_mov_b64 v[192:193], 0
    v_mov_b64 v[194:195], 0
    v_mov_b64 v[196:197], 0
    v_mov_b64 v[198:199], 0
    v_mov_b64 v[200:201], 0
    v_mov_b64 v[202:203], 0
    v_mov_b64 v[204:205], 0
    v_mov_b64 v[206:207], 0
    v_mov_b64 v[208:209], 0
    v_mov_b64 v[210:211], 0
    v_mov_b64 v[212:213], 0
    v_mov_b64 v[214:215], 0
    v_mov_b64 v[216:217], 0
    v_mov_b64 v[218:219], 0
    v_mov_b64 v[220:221], 0
    v_mov_b64 v[222:223], 0
    v_mov_b64 v[224:225], 0
    v_mov_b64 v[226:227], 0
    v_mov_b64 v[228:229], 0
    v_mov_b64 v[230:231], 0
    v_mov_b64 v[232:233], 0
    v_mov_b64 v[234:235], 0
    v_mov_b64 v[236:237], 0
    v_mov_b64 v[238:239], 0
    v_mov_b64 v[240:241], 0
    v_mov_b64 v[242:243], 0
    v_mov_b64 v[244:245], 0
    v_mov_b64 v[246:247], 0
    v_mov_b64 v[248:249], 0
    v_mov_b64 v[250:251], 0
    v_mov_b64 v[252:253], 0
    v_mov_b64 v[254:255], 0
    s_mul_i32 s45, s44, 33792
    s_add_u32 s48, s45, 16896
    s_add_u32 s44, s44, 1
    s_and_b32 s44, s44, s51
    s_mul_i32 s49, s44, 33792
    s_cmp_eq_u32 s100, 0
    s_cselect_b32 s45, s48, s45
    s_cselect_b32 s48, s49, s48
    s_addc_u32 s44, s44, 0
    s_and_b32 s44, s44, s51
    s_mul_i32 s49, s57, 8448
    s_add_u32 s48, s48, s49
    v_add_u32 v5, s48, v3
    v_add_u32 v1, s45, v3
    s_mul_i32 s45, s44, 33792
    v_add_u32 v2, s45, v4
    s_sub_u32 s46, s42, 2
    s_waitcnt vmcnt(3)
    v_lshlrev_b32 v32, 16, v112
    v_and_b32 v33, 0xffff0000, v112
    v_pk_mul_f32 v[32:33], v[32:33], s[50:51] op_sel_hi:[1,0]
    v_cvt_pk_bf16_f32 v112, v32, v33
    v_lshlrev_b32 v34, 16, v113
    v_and_b32 v35, 0xffff0000, v113
    v_pk_mul_f32 v[34:35], v[34:35], s[50:51] op_sel_hi:[1,0]
    v_cvt_pk_bf16_f32 v113, v34, v35
    v_lshlrev_b32 v36, 16, v114
    v_and_b32 v37, 0xffff0000, v114
    v_pk_mul_f32 v[36:37], v[36:37], s[50:51] op_sel_hi:[1,0]
    v_cvt_pk_bf16_f32 v114, v36, v37
    v_lshlrev_b32 v38, 16, v115
    v_and_b32 v39, 0xffff0000, v115
    v_pk_mul_f32 v[38:39], v[38:39], s[50:51] op_sel_hi:[1,0]
    v_cvt_pk_bf16_f32 v115, v38, v39
    ds_write_b128 v80, v[112:115] offset:0
    s_waitcnt vmcnt(2)
    v_lshlrev_b32 v32, 16, v116
    v_and_b32 v33, 0xffff0000, v116
    v_pk_mul_f32 v[32:33], v[32:33], s[50:51] op_sel_hi:[1,0]
    v_cvt_pk_bf16_f32 v116, v32, v33
    v_lshlrev_b32 v34, 16, v117
    v_and_b32 v35, 0xffff0000, v117
    v_pk_mul_f32 v[34:35], v[34:35], s[50:51] op_sel_hi:[1,0]
    v_cvt_pk_bf16_f32 v117, v34, v35
    v_lshlrev_b32 v36, 16, v118
    v_and_b32 v37, 0xffff0000, v118
    v_pk_mul_f32 v[36:37], v[36:37], s[50:51] op_sel_hi:[1,0]
    v_cvt_pk_bf16_f32 v118, v36, v37
    v_lshlrev_b32 v38, 16, v119
    v_and_b32 v39, 0xffff0000, v119
    v_pk_mul_f32 v[38:39], v[38:39], s[50:51] op_sel_hi:[1,0]
    v_cvt_pk_bf16_f32 v119, v38, v39
    ds_write_b128 v80, v[116:119] offset:1056
    s_waitcnt vmcnt(1)
    v_lshlrev_b32 v32, 16, v120
    v_and_b32 v33, 0xffff0000, v120
    v_pk_mul_f32 v[32:33], v[32:33], s[50:51] op_sel_hi:[1,0]
    v_cvt_pk_bf16_f32 v120, v32, v33
    v_lshlrev_b32 v34, 16, v121
    v_and_b32 v35, 0xffff0000, v121
    v_pk_mul_f32 v[34:35], v[34:35], s[50:51] op_sel_hi:[1,0]
    v_cvt_pk_bf16_f32 v121, v34, v35
    v_lshlrev_b32 v36, 16, v122
    v_and_b32 v37, 0xffff0000, v122
    v_pk_mul_f32 v[36:37], v[36:37], s[50:51] op_sel_hi:[1,0]
    v_cvt_pk_bf16_f32 v122, v36, v37
    v_lshlrev_b32 v38, 16, v123
    v_and_b32 v39, 0xffff0000, v123
    v_pk_mul_f32 v[38:39], v[38:39], s[50:51] op_sel_hi:[1,0]
    v_cvt_pk_bf16_f32 v123, v38, v39
    ds_write_b128 v80, v[120:123] offset:8448
    s_waitcnt vmcnt(0)
    v_lshlrev_b32 v32, 16, v124
    v_and_b32 v33, 0xffff0000, v124
    v_pk_mul_f32 v[32:33], v[32:33], s[50:51] op_sel_hi:[1,0]
    v_cvt_pk_bf16_f32 v124, v32, v33
    v_lshlrev_b32 v34, 16, v125
    v_and_b32 v35, 0xffff0000, v125
    v_pk_mul_f32 v[34:35], v[34:35], s[50:51] op_sel_hi:[1,0]
    v_cvt_pk_bf16_f32 v125, v34, v35
    v_lshlrev_b32 v36, 16, v126
    v_and_b32 v37, 0xffff0000, v126
    v_pk_mul_f32 v[36:37], v[36:37], s[50:51] op_sel_hi:[1,0]
    v_cvt_pk_bf16_f32 v126, v36, v37
    v_lshlrev_b32 v38, 16, v127
    v_and_b32 v39, 0xffff0000, v127
    v_pk_mul_f32 v[38:39], v[38:39], s[50:51] op_sel_hi:[1,0]
    v_cvt_pk_bf16_f32 v127, v38, v39
    ds_write_b128 v80, v[124:127] offset:9504
    s_waitcnt lgkmcnt(0)
L_cround:
    s_cmp_ge_u32 s60, s43
    s_barrier
    s_cbranch_scc1 L_idle
L_busy:
    ds_read_b128 v[112:115], v5 offset:0
    ds_read_b128 v[80:83], v1 offset:0
    ds_read_b128 v[84:87], v1 offset:512
    ds_read_b128 v[128:131], v5 offset:512
    ds_read_b128 v[116:119], v5 offset:64
    ds_read_b128 v[88:91], v1 offset:64
    s_waitcnt lgkmcnt(4)
    v_mfma_f32_16x16x32_bf16 v[160:163], v[80:83], v[112:115], 0
    ds_read_b128 v[92:95], v1 offset:576
    s_waitcnt lgkmcnt(4)
    v_mfma_f32_16x16x32_bf16 v[164:167], v[84:87], v[112:115], 0
    ds_read_b128 v[132:135], v5 offset:576
    s_waitcnt lgkmcnt(4)
    v_mfma_f32_16x16x32_bf16 v[168:171], v[80:83], v[128:131], 0
    ds_read_b128 v[120:123], v5 offset:128
    v_mfma_f32_16x16x32_bf16 v[172:175], v[84:87], v[128:131], 0
    ds_read_b128 v[96:99], v1 offset:128
    s_waitcnt lgkmcnt(4)
    v_mfma_f32_16x16x32_bf16 v[160:163], v[88:91], v[116:119], v[160:163]
    ds_read_b128 v[100:103], v1 offset:640
    s_waitcnt lgkmcnt(4)
    v_mfma_f32_16x16x32_bf16 v[164:167], v[92:95], v[116:119], v[164:167]
    ds_read_b128 v[136:139], v5 offset:640
    s_waitcnt lgkmcnt(4)
    v_mfma_f32_16x16x32_bf16 v[168:171], v[88:91], v[132:135], v[168:171]
    ds_read_b128 v[124:127], v5 offset:192
    v_mfma_f32_16x16x32_bf16 v[172:175], v[92:95], v[132:135], v[172:175]
    ds_read_b128 v[104:107], v1 offset:192
    s_waitcnt lgkmcnt(4)
    v_mfma_f32_16x16x32_bf16 v[160:163], v[96:99], v[120:123], v[160:163]
    ds_read_b128 v[108:111], v1 offset:704
    s_waitcnt lgkmcnt(4)
    v_mfma_f32_16x16x32_bf16 v[164:167], v[100:103], v[120:123], v[164:167]
    ds_read_b128 v[140:143], v5 offset:704
    s_waitcnt lgkmcnt(4)
    v_mfma_f32_16x16x32_bf16 v[168:171], v[96:99], v[136:139], v[168:171]
    v_mfma_f32_16x16x32_bf16 v[172:175], v[100:103], v[136:139], v[172:175]
    s_waitcnt lgkmcnt(2)
    v_mfma_f32_16x16x32_bf16 v[160:163], v[104:107], v[124:127], v[160:163]
    s_waitcnt lgkmcnt(1)
    v_mfma_f32_16x16x32_bf16 v[164:167], v[108:111], v[124:127], v[164:167]
    s_waitcnt lgkmcnt(0)
    v_mfma_f32_16x16x32_bf16 v[168:171], v[104:107], v[140:143], v[168:171]
    v_mfma_f32_16x16x32_bf16 v[172:175], v[108:111], v[140:143], v[172:175]
    ds_read_b128 v[80:83], v1 offset:8448
    ds_read_b128 v[84:87], v1 offset:8960
    ds_read_b128 v[88:91], v1 offset:8512
    ds_read_b128 v[92:95], v1 offset:9024
    ds_read_b128 v[96:99], v1 offset:8576
    ds_read_b128 v[100:103], v1 offset:9088
    s_nop 1
    v_exp_f32 v160, v160
    v_exp_f32 v161, v161
    v_exp_f32 v162, v162
    v_exp_f32 v163, v163
    v_cvt_pk_bf16_f32 v40, v160, v161
    ds_read_b128 v[104:107], v1 offset:8640
    ds_read_b128 v[108:111], v1 offset:9152
    v_add_u32 v1, s45, v3
    v_exp_f32 v164, v164
    v_exp_f32 v165, v165
    v_cvt_pk_bf16_f32 v41, v162, v163
    v_exp_f32 v166, v166
    v_exp_f32 v167, v167
    v_cvt_pk_bf16_f32 v42, v164, v165
    s_nop 0
    v_cvt_pk_bf16_f32 v43, v166, v167
    s_barrier
    s_waitcnt lgkmcnt(4)
.p2align 6
L_h0:
    v_mfma_f32_16x16x32_bf16 v[176:179], v[80:83], v[112:115], 0
    ds_read_b64_tr_b16 v[48:49], v2 offset:0
    ds_read_b64_tr_b16 v[50:51], v2 offset:512
    v_mfma_f32_16x16x32_bf16 v[180:183], v[84:87], v[112:115], 0
    v_exp_f32 v168, v168
    v_mfma_f32_16x16x32_bf16 v[184:187], v[80:83], v[128:131], 0
    ds_read_b64_tr_b16 v[52:53], v2 offset:32
    ds_read_b64_tr_b16 v[54:55], v2 offset:544
    v_mfma_f32_16x16x32_bf16 v[188:191], v[84:87], v[128:131], 0
    v_exp_f32 v169, v169
    v_mfma_f32_16x16x32_bf16 v[176:179], v[88:91], v[116:119], v[176:179]
    ds_read_b64_tr_b16 v[56:57], v2 offset:64
    ds_read_b64_tr_b16 v[58:59], v2 offset:576
    v_mfma_f32_16x16x32_bf16 v[180:183], v[92:95], v[116:119], v[180:183]
    v_exp_f32 v170, v170
    v_mfma_f32_16x16x32_bf16 v[184:187], v[88:91], v[132:135], v[184:187]
    ds_read_b64_tr_b16 v[60:61], v2 offset:96
    ds_read_b64_tr_b16 v[62:63], v2 offset:608
    v_mfma_f32_16x16x32_bf16 v[188:191], v[92:95], v[132:135], v[188:191]
    s_waitcnt lgkmcnt(8)
    v_exp_f32 v171, v171
    v_mfma_f32_16x16x32_bf16 v[176:179], v[96:99], v[120:123], v[176:179]
    ds_read_b64_tr_b16 v[64:65], v2 offset:128
    ds_read_b64_tr_b16 v[66:67], v2 offset:640
    v_mfma_f32_16x16x32_bf16 v[180:183], v[100:103], v[120:123], v[180:183]
    v_cvt_pk_bf16_f32 v44, v168, v169
    v_cvt_pk_bf16_f32 v45, v170, v171
    v_mfma_f32_16x16x32_bf16 v[184:187], v[96:99], v[136:139], v[184:187]
    ds_read_b64_tr_b16 v[68:69], v2 offset:160
    ds_read_b64_tr_b16 v[70:71], v2 offset:672
    v_mfma_f32_16x16x32_bf16 v[188:191], v[100:103], v[136:139], v[188:191]
    v_exp_f32 v172, v172
    v_mfma_f32_16x16x32_bf16 v[176:179], v[104:107], v[124:127], v[176:179]
    ds_read_b64_tr_b16 v[72:73], v2 offset:192
    ds_read_b64_tr_b16 v[74:75], v2 offset:704
    v_mfma_f32_16x16x32_bf16 v[180:183], v[108:111], v[124:127], v[180:183]
    v_exp_f32 v173, v173
    v_mfma_f32_16x16x32_bf16 v[184:187], v[104:107], v[140:143], v[184:187]
    ds_read_b64_tr_b16 v[76:77], v2 offset:224
    ds_read_b64_tr_b16 v[78:79], v2 offset:736
    v_mfma_f32_16x16x32_bf16 v[188:191], v[108:111], v[140:143], v[188:191]
    s_waitcnt lgkmcnt(8)
    v_exp_f32 v174, v174
    v_mfma_f32_16x16x32_bf16 v[192:195], v[48:51], v[40:43], v[192:195]
    ds_read_b128 v[80:83], v1 offset:8448
    ds_read_b128 v[84:87], v1 offset:8960
    v_mfma_f32_16x16x32_bf16 v[196:199], v[52:55], v[40:43], v[196:199]
    v_exp_f32 v175, v175
    v_mfma_f32_16x16x32_bf16 v[200:203], v[56:59], v[40:43], v[200:203]
    ds_read_b128 v[88:91], v1 offset:8512
    v_cvt_pk_bf16_f32 v46, v172, v173
    v_mfma_f32_16x16x32_bf16 v[204:207], v[60:63], v[40:43], v[204:207]
    s_waitcnt lgkmcnt(3)
    v_exp_f32 v176, v176
    v_mfma_f32_16x16x32_bf16 v[208:211], v[64:67], v[40:43], v[208:211]
    ds_read_b128 v[92:95], v1 offset:9024
    v_cvt_pk_bf16_f32 v47, v174, v175
    v_mfma_f32_16x16x32_bf16 v[212:215], v[68:71], v[40:43], v[212:215]
    v_exp_f32 v177, v177
    v_mfma_f32_16x16x32_bf16 v[216:219], v[72:75], v[40:43], v[216:219]
    ds_read_b128 v[96:99], v1 offset:8576
    ds_read_b128 v[100:103], v1 offset:9088
    v_mfma_f32_16x16x32_bf16 v[220:223], v[76:79], v[40:43], v[220:223]
    v_exp_f32 v178, v178
    v_mfma_f32_16x16x32_bf16 v[144:147], v[152:155], v[40:43], v[144:147]
    ds_read_b128 v[104:107], v1 offset:8640
    ds_read_b128 v[108:111], v1 offset:9152
    v_mfma_f32_16x16x32_bf16 v[224:227], v[48:51], v[44:47], v[224:227]
    s_barrier
    v_mfma_f32_16x16x32_bf16 v[228:231], v[52:55], v[44:47], v[228:231]
    s_add_u32 s44, s44, 1
    v_exp_f32 v179, v179
    v_mfma_f32_16x16x32_bf16 v[232:235], v[56:59], v[44:47], v[232:235]
    s_and_b32 s44, s44, s51
    v_exp_f32 v180, v180
    v_mfma_f32_16x16x32_bf16 v[236:239], v[60:63], v[44:47], v[236:239]
    s_mul_i32 s45, s44, 33792
    v_exp_f32 v181, v181
    v_mfma_f32_16x16x32_bf16 v[240:243], v[64:67], v[44:47], v[240:243]
    s_sub_u32 s46, s46, 1
    v_exp_f32 v182, v182
    v_mfma_f32_16x16x32_bf16 v[244:247], v[68:71], v[44:47], v[244:247]
    v_exp_f32 v183, v183
    v_mfma_f32_16x16x32_bf16 v[248:251], v[72:75], v[44:47], v[248:251]
    v_cvt_pk_bf16_f32 v40, v176, v177
    v_cvt_pk_bf16_f32 v41, v178, v179
    v_mfma_f32_16x16x32_bf16 v[252:255], v[76:79], v[44:47], v[252:255]
    s_waitcnt lgkmcnt(4)
    v_cvt_pk_bf16_f32 v42, v180, v181
    v_cvt_pk_bf16_f32 v43, v182, v183
    v_mfma_f32_16x16x32_bf16 v[148:151], v[152:155], v[44:47], v[148:151]
    s_cbranch_scc1 L_tail1
L_h1:
    v_mfma_f32_16x16x32_bf16 v[160:163], v[80:83], v[112:115], 0
    ds_read_b64_tr_b16 v[48:49], v2 offset:16896
    ds_read_b64_tr_b16 v[50:51], v2 offset:17408
    v_mfma_f32_16x16x32_bf16 v[164:167], v[84:87], v[112:115], 0
    v_exp_f32 v184, v184
    v_mfma_f32_16x16x32_bf16 v[168:171], v[80:83], v[128:131], 0
    ds_read_b64_tr_b16 v[52:53], v2 offset:16928
    ds_read_b64_tr_b16 v[54:55], v2 offset:17440
    v_mfma_f32_16x16x32_bf16 v[172:175], v[84:87], v[128:131], 0
    v_exp_f32 v185, v185
    v_mfma_f32_16x16x32_bf16 v[160:163], v[88:91], v[116:119], v[160:163]
    ds_read_b64_tr_b16 v[56:57], v2 offset:16960
    ds_read_b64_tr_b16 v[58:59], v2 offset:17472
    v_mfma_f32_16x16x32_bf16 v[164:167], v[92:95], v[116:119], v[164:167]
    v_exp_f32 v186, v186
    v_mfma_f32_16x16x32_bf16 v[168:171], v[88:91], v[132:135], v[168:171]
    ds_read_b64_tr_b16 v[60:61], v2 offset:16992
    ds_read_b64_tr_b16 v[62:63], v2 offset:17504
    v_mfma_f32_16x16x32_bf16 v[172:175], v[92:95], v[132:135], v[172:175]
    s_waitcnt lgkmcnt(8)
    v_exp_f32 v187, v187
    v_mfma_f32_16x16x32_bf16 v[160:163], v[96:99], v[120:123], v[160:163]
    ds_read_b64_tr_b16 v[64:65], v2 offset:17024
    ds_read_b64_tr_b16 v[66:67], v2 offset:17536
    v_mfma_f32_16x16x32_bf16 v[164:167], v[100:103], v[120:123], v[164:167]
    v_cvt_pk_bf16_f32 v44, v184, v185
    v_cvt_pk_bf16_f32 v45, v186, v187
    v_mfma_f32_16x16x32_bf16 v[168:171], v[96:99], v[136:139], v[168:171]
    ds_read_b64_tr_b16 v[68:69], v2 offset:17056
    ds_read_b64_tr_b16 v[70:71], v2 offset:17568
    v_mfma_f32_16x16x32_bf16 v[172:175], v[100:103], v[136:139], v[172:175]
    v_exp_f32 v188, v188
    v_mfma_f32_16x16x32_bf16 v[160:163], v[104:107], v[124:127], v[160:163]
    ds_read_b64_tr_b16 v[72:73], v2 offset:17088
    ds_read_b64_tr_b16 v[74:75], v2 offset:17600
    v_mfma_f32_16x16x32_bf16 v[164:167], v[108:111], v[124:127], v[164:167]
    v_exp_f32 v189, v189
    v_mfma_f32_16x16x32_bf16 v[168:171], v[104:107], v[140:143], v[168:171]
    ds_read_b64_tr_b16 v[76:77], v2 offset:17120
    ds_read_b64_tr_b16 v[78:79], v2 offset:17632
    v_mfma_f32_16x16x32_bf16 v[172:175], v[108:111], v[140:143], v[172:175]
    s_waitcnt lgkmcnt(8)
    v_exp_f32 v190, v190
    v_mfma_f32_16x16x32_bf16 v[192:195], v[48:51], v[40:43], v[192:195]
    ds_read_b128 v[80:83], v1 offset:25344
    ds_read_b128 v[84:87], v1 offset:25856
    v_mfma_f32_16x16x32_bf16 v[196:199], v[52:55], v[40:43], v[196:199]
    v_exp_f32 v191, v191
    v_mfma_f32_16x16x32_bf16 v[200:203], v[56:59], v[40:43], v[200:203]
    ds_read_b128 v[88:91], v1 offset:25408
    v_cvt_pk_bf16_f32 v46, v188, v189
    v_mfma_f32_16x16x32_bf16 v[204:207], v[60:63], v[40:43], v[204:207]
    s_waitcnt lgkmcnt(3)
    v_exp_f32 v160, v160
    v_mfma_f32_16x16x32_bf16 v[208:211], v[64:67], v[40:43], v[208:211]
    ds_read_b128 v[92:95], v1 offset:25920
    v_cvt_pk_bf16_f32 v47, v190, v191
    v_mfma_f32_16x16x32_bf16 v[212:215], v[68:71], v[40:43], v[212:215]
    v_exp_f32 v161, v161
    v_mfma_f32_16x16x32_bf16 v[216:219], v[72:75], v[40:43], v[216:219]
    ds_read_b128 v[96:99], v1 offset:25472
    ds_read_b128 v[100:103], v1 offset:25984
    v_mfma_f32_16x16x32_bf16 v[220:223], v[76:79], v[40:43], v[220:223]
    v_exp_f32 v162, v162
    v_mfma_f32_16x16x32_bf16 v[144:147], v[152:155], v[40:43], v[144:147]
    ds_read_b128 v[104:107], v1 offset:25536
    ds_read_b128 v[108:111], v1 offset:26048
    v_mfma_f32_16x16x32_bf16 v[224:227], v[48:51], v[44:47], v[224:227]
    s_barrier
    v_mfma_f32_16x16x32_bf16 v[228:231], v[52:55], v[44:47], v[228:231]
    v_exp_f32 v163, v163
    v_mfma_f32_16x16x32_bf16 v[232:235], v[56:59], v[44:47], v[232:235]
    v_exp_f32 v164, v164
    v_mfma_f32_16x16x32_bf16 v[236:239], v[60:63], v[44:47], v[236:239]
    v_exp_f32 v165, v165
    v_mfma_f32_16x16x32_bf16 v[240:243], v[64:67], v[44:47], v[240:243]
    s_sub_u32 s46, s46, 1
    v_exp_f32 v166, v166
    v_mfma_f32_16x16x32_bf16 v[244:247], v[68:71], v[44:47], v[244:247]
    v_exp_f32 v167, v167
    v_mfma_f32_16x16x32_bf16 v[248:251], v[72:75], v[44:47], v[248:251]
    v_cvt_pk_bf16_f32 v40, v160, v161
    v_cvt_pk_bf16_f32 v41, v162, v163
    v_mfma_f32_16x16x32_bf16 v[252:255], v[76:79], v[44:47], v[252:255]
    s_waitcnt lgkmcnt(4)
    v_cvt_pk_bf16_f32 v42, v164, v165
    v_cvt_pk_bf16_f32 v43, v166, v167
    v_mfma_f32_16x16x32_bf16 v[148:151], v[152:155], v[44:47], v[148:151]
    v_add_u32 v2, s45, v4
    v_add_u32 v1, s45, v3
    s_cbranch_scc0 L_h0
L_tail0:
    ds_read_b64_tr_b16 v[48:49], v2 offset:0
    ds_read_b64_tr_b16 v[50:51], v2 offset:512
    ds_read_b64_tr_b16 v[52:53], v2 offset:32
    ds_read_b64_tr_b16 v[54:55], v2 offset:544
    ds_read_b64_tr_b16 v[56:57], v2 offset:64
    ds_read_b64_tr_b16 v[58:59], v2 offset:576
    v_exp_f32 v168, v168
    v_exp_f32 v169, v169
    v_mfma_f32_16x16x32_bf16 v[144:147], v[156:159], v[40:43], v[144:147]
    ds_read_b64_tr_b16 v[60:61], v2 offset:96
    ds_read_b64_tr_b16 v[62:63], v2 offset:608
    s_waitcnt lgkmcnt(6)
    v_mfma_f32_16x16x32_bf16 v[192:195], v[48:51], v[40:43], v[192:195]
    v_exp_f32 v170, v170
    s_waitcnt lgkmcnt(4)
    v_mfma_f32_16x16x32_bf16 v[196:199], v[52:55], v[40:43], v[196:199]
    ds_read_b64_tr_b16 v[64:65], v2 offset:128
    ds_read_b64_tr_b16 v[66:67], v2 offset:640
    s_waitcnt lgkmcnt(4)
    v_mfma_f32_16x16x32_bf16 v[200:203], v[56:59], v[40:43], v[200:203]
    v_exp_f32 v171, v171
    s_waitcnt lgkmcnt(2)
    v_mfma_f32_16x16x32_bf16 v[204:207], v[60:63], v[40:43], v[204:207]
    ds_read_b64_tr_b16 v[68:69], v2 offset:160
    ds_read_b64_tr_b16 v[70:71], v2 offset:672
    s_waitcnt lgkmcnt(2)
    v_mfma_f32_16x16x32_bf16 v[208:211], v[64:67], v[40:43], v[208:211]
    ds_read_b64_tr_b16 v[72:73], v2 offset:192
    ds_read_b64_tr_b16 v[74:75], v2 offset:704
    ds_read_b64_tr_b16 v[76:77], v2 offset:224
    ds_read_b64_tr_b16 v[78:79], v2 offset:736
    v_exp_f32 v172, v172
    v_exp_f32 v173, v173
    s_waitcnt lgkmcnt(4)
    v_mfma_f32_16x16x32_bf16 v[212:215], v[68:71], v[40:43], v[212:215]
    v_exp_f32 v174, v174
    s_waitcnt lgkmcnt(2)
    v_mfma_f32_16x16x32_bf16 v[216:219], v[72:75], v[40:43], v[216:219]
    v_exp_f32 v175, v175
    s_waitcnt lgkmcnt(0)
    v_mfma_f32_16x16x32_bf16 v[220:223], v[76:79], v[40:43], v[220:223]
    v_cvt_pk_bf16_f32 v44, v168, v169
    v_cvt_pk_bf16_f32 v45, v170, v171
    v_cvt_pk_bf16_f32 v46, v172, v173
    v_cvt_pk_bf16_f32 v47, v174, v175
    s_branch L_epi
L_tail1:
    ds_read_b64_tr_b16 v[48:49], v2 offset:16896
    ds_read_b64_tr_b16 v[50:51], v2 offset:17408
    ds_read_b64_tr_b16 v[52:53], v2 offset:16928
    ds_read_b64_tr_b16 v[54:55], v2 offset:17440
    ds_read_b64_tr_b16 v[56:57], v2 offset:16960
    ds_read_b64_tr_b16 v[58:59], v2 offset:17472
    v_exp_f32 v184, v184
    v_exp_f32 v185, v185
    v_mfma_f32_16x16x32_bf16 v[144:147], v[156:159], v[40:43], v[144:147]
    ds_read_b64_tr_b16 v[60:61], v2 offset:16992
    ds_read_b64_tr_b16 v[62:63], v2 offset:17504
    s_waitcnt lgkmcnt(6)
    v_mfma_f32_16x16x32_bf16 v[192:195], v[48:51], v[40:43], v[192:195]
    v_exp_f32 v186, v186
    s_waitcnt lgkmcnt(4)
    v_mfma_f32_16x16x32_bf16 v[196:199], v[52:55], v[40:43], v[196:199]
    ds_read_b64_tr_b16 v[64:65], v2 offset:17024
    ds_read_b64_tr_b16 v[66:67], v2 offset:17536
    s_waitcnt lgkmcnt(4)
    v_mfma_f32_16x16x32_bf16 v[200:203], v[56:59], v[40:43], v[200:203]
    v_exp_f32 v187, v187
    s_waitcnt lgkmcnt(2)
    v_mfma_f32_16x16x32_bf16 v[204:207], v[60:63], v[40:43], v[204:207]
    ds_read_b64_tr_b16 v[68:69], v2 offset:17056
    ds_read_b64_tr_b16 v[70:71], v2 offset:17568
    s_waitcnt lgkmcnt(2)
    v_mfma_f32_16x16x32_bf16 v[208:211], v[64:67], v[40:43], v[208:211]
    ds_read_b64_tr_b16 v[72:73], v2 offset:17088
    ds_read_b64_tr_b16 v[74:75], v2 offset:17600
    ds_read_b64_tr_b16 v[76:77], v2 offset:17120
    ds_read_b64_tr_b16 v[78:79], v2 offset:17632
    v_exp_f32 v188, v188
    v_exp_f32 v189, v189
    s_waitcnt lgkmcnt(4)
    v_mfma_f32_16x16x32_bf16 v[212:215], v[68:71], v[40:43], v[212:215]
    v_exp_f32 v190, v190
    s_waitcnt lgkmcnt(2)
    v_mfma_f32_16x16x32_bf16 v[216:219], v[72:75], v[40:43], v[216:219]
    v_exp_f32 v191, v191
    s_waitcnt lgkmcnt(0)
    v_mfma_f32_16x16x32_bf16 v[220:223], v[76:79], v[40:43], v[220:223]
    v_cvt_pk_bf16_f32 v44, v184, v185
    v_cvt_pk_bf16_f32 v45, v186, v187
    v_cvt_pk_bf16_f32 v46, v188, v189
    v_cvt_pk_bf16_f32 v47, v190, v191
L_epi:
    v_rcp_f32 v16, v144
    v_cmp_gt_f32 vcc, s98, v144
    v_mfma_f32_16x16x32_bf16 v[148:151], v[156:159], v[44:47], v[148:151]
    v_cmp_lt_f32 s[64:65], s99, v144
    v_mfma_f32_16x16x32_bf16 v[224:227], v[48:51], v[44:47], v[224:227]
    v_mul_f32 v192, v16, v192
    v_mul_f32 v193, v16, v193
    v_mfma_f32_16x16x32_bf16 v[228:231], v[52:55], v[44:47], v[228:231]
    s_and_b64 vcc, vcc, s[64:65]
    v_mul_f32 v194, v16, v194
    v_mul_f32 v195, v16, v195
    v_mfma_f32_16x16x32_bf16 v[232:235], v[56:59], v[44:47], v[232:235]
    v_cvt_pk_bf16_f32 v112, v192, v193
    v_cvt_pk_bf16_f32 v113, v194, v195
    v_mfma_f32_16x16x32_bf16 v[236:239], v[60:63], v[44:47], v[236:239]
    v_mul_f32 v196, v16, v196
    v_mul_f32 v197, v16, v197
    v_mfma_f32_16x16x32_bf16 v[240:243], v[64:67], v[44:47], v[240:243]
    v_rcp_f32 v17, v148
    v_mfma_f32_16x16x32_bf16 v[244:247], v[68:71], v[44:47], v[244:247]
    v_mul_f32 v198, v16, v198
    v_mul_f32 v199, v16, v199
    v_mfma_f32_16x16x32_bf16 v[248:251], v[72:75], v[44:47], v[248:251]
    v_cvt_pk_bf16_f32 v114, v196, v197
    v_cvt_pk_bf16_f32 v115, v198, v199
    v_mfma_f32_16x16x32_bf16 v[252:255], v[76:79], v[44:47], v[252:255]
    ds_write2_b64 v9, v[112:113], v[114:115] offset0:0 offset1:4
    v_cmp_gt_f32 s[64:65], s98, v148
    v_cmp_lt_f32 s[66:67], s99, v148
    v_mul_f32 v200, v16, v200
    v_mul_f32 v201, v16, v201
    v_mul_f32 v202, v16, v202
    v_mul_f32 v203, v16, v203
    v_cvt_pk_bf16_f32 v116, v200, v201
    v_cvt_pk_bf16_f32 v117, v202, v203
    s_and_b64 vcc, vcc, s[64:65]
    s_and_b64 vcc, vcc, s[66:67]
    v_pk_mul_f32 v[204:205], v[204:205], v[16:17] op_sel_hi:[1,0]
    v_pk_mul_f32 v[206:207], v[206:207], v[16:17] op_sel_hi:[1,0]
    v_cvt_pk_bf16_f32 v118, v204, v205
    v_cvt_pk_bf16_f32 v119, v206, v207
    ds_write2_b64 v9, v[116:117], v[118:119] offset0:8 offset1:12
    s_cmp_eq_u64 vcc, -1
    s_cselect_b32 s48, 0, s59
    s_or_b32 s58, s58, s48
    v_pk_mul_f32 v[208:209], v[208:209], v[16:17] op_sel_hi:[1,0]
    v_pk_mul_f32 v[210:211], v[210:211], v[16:17] op_sel_hi:[1,0]
    v_cvt_pk_bf16_f32 v120, v208, v209
    v_cvt_pk_bf16_f32 v121, v210, v211
    v_pk_mul_f32 v[212:213], v[212:213], v[16:17] op_sel_hi:[1,0]
    v_pk_mul_f32 v[214:215], v[214:215], v[16:17] op_sel_hi:[1,0]
    v_cvt_pk_bf16_f32 v122, v212, v213
    v_cvt_pk_bf16_f32 v123, v214, v215
    ds_write2_b64 v9, v[120:121], v[122:123] offset0:16 offset1:20
    v_pk_mul_f32 v[216:217], v[216:217], v[16:17] op_sel_hi:[1,0]
    v_pk_mul_f32 v[218:219], v[218:219], v[16:17] op_sel_hi:[1,0]
    v_cvt_pk_bf16_f32 v124, v216, v217
    v_cvt_pk_bf16_f32 v125, v218, v219
    v_pk_mul_f32 v[220:221], v[220:221], v[16:17] op_sel_hi:[1,0]
    v_pk_mul_f32 v[222:223], v[222:223], v[16:17] op_sel_hi:[1,0]
    v_cvt_pk_bf16_f32 v126, v220, v221
    v_cvt_pk_bf16_f32 v127, v222, v223
    ds_write2_b64 v9, v[124:125], v[126:127] offset0:24 offset1:28
    ds_read_b128 v[80:83], v11 offset:0
    ds_read_b128 v[84:87], v11 offset:1088
    ds_read_b128 v[88:91], v11 offset:2176
    ds_read_b128 v[92:95], v11 offset:3264
    v_pk_mul_f32 v[224:225], v[224:225], v[16:17] op_sel:[0,1]
    v_pk_mul_f32 v[226:227], v[226:227], v[16:17] op_sel:[0,1]
    v_cvt_pk_bf16_f32 v128, v224, v225
    v_cvt_pk_bf16_f32 v129, v226, v227
    s_waitcnt lgkmcnt(3)
    buffer_store_dwordx4 v[80:83], v7, s[32:35], s60 offen sc0 sc1
    v_pk_mul_f32 v[228:229], v[228:229], v[16:17] op_sel:[0,1]
    v_pk_mul_f32 v[230:231], v[230:231], v[16:17] op_sel:[0,1]
    v_cvt_pk_bf16_f32 v130, v228, v229
    v_cvt_pk_bf16_f32 v131, v230, v231
    ds_write2_b64 v9, v[128:129], v[130:131] offset0:0 offset1:4
    s_waitcnt lgkmcnt(3)
    buffer_store_dwordx4 v[84:87], v7, s[32:35], s61 offen sc0 sc1
    v_pk_mul_f32 v[232:233], v[232:233], v[16:17] op_sel:[0,1]
    v_pk_mul_f32 v[234:235], v[234:235], v[16:17] op_sel:[0,1]
    v_cvt_pk_bf16_f32 v132, v232, v233
    v_cvt_pk_bf16_f32 v133, v234, v235
    v_pk_mul_f32 v[236:237], v[236:237], v[16:17] op_sel:[0,1]
    v_pk_mul_f32 v[238:239], v[238:239], v[16:17] op_sel:[0,1]
    v_cvt_pk_bf16_f32 v134, v236, v237
    v_cvt_pk_bf16_f32 v135, v238, v239
    ds_write2_b64 v9, v[132:133], v[134:135] offset0:8 offset1:12
    s_waitcnt lgkmcnt(3)
    buffer_store_dwordx4 v[88:91], v7, s[32:35], s62 offen sc0 sc1
    v_pk_mul_f32 v[240:241], v[240:241], v[16:17] op_sel:[0,1]
    v_pk_mul_f32 v[242:243], v[242:243], v[16:17] op_sel:[0,1]
    v_cvt_pk_bf16_f32 v136, v240, v241
    v_cvt_pk_bf16_f32 v137, v242, v243
    v_pk_mul_f32 v[244:245], v[244:245], v[16:17] op_sel:[0,1]
    v_pk_mul_f32 v[246:247], v[246:247], v[16:17] op_sel:[0,1]
    v_cvt_pk_bf16_f32 v138, v244, v245
    v_cvt_pk_bf16_f32 v139, v246, v247
    ds_write2_b64 v9, v[136:137], v[138:139] offset0:16 offset1:20
    s_waitcnt lgkmcnt(3)
    buffer_store_dwordx4 v[92:95], v7, s[32:35], s63 offen sc0 sc1
    v_pk_mul_f32 v[248:249], v[248:249], v[16:17] op_sel:[0,1]
    v_pk_mul_f32 v[250:251], v[250:251], v[16:17] op_sel:[0,1]
    v_cvt_pk_bf16_f32 v140, v248, v249
    v_cvt_pk_bf16_f32 v141, v250, v251
    v_pk_mul_f32 v[252:253], v[252:253], v[16:17] op_sel:[0,1]
    v_pk_mul_f32 v[254:255], v[254:255], v[16:17] op_sel:[0,1]
    v_cvt_pk_bf16_f32 v142, v252, v253
    v_cvt_pk_bf16_f32 v143, v254, v255
    ds_write2_b64 v9, v[140:141], v[142:143] offset0:24 offset1:28
    ds_read_b128 v[96:99], v11 offset:0
    ds_read_b128 v[100:103], v11 offset:1088
    ds_read_b128 v[104:107], v11 offset:2176
    ds_read_b128 v[108:111], v11 offset:3264
    s_cmp_lg_u32 s37, 0
    s_cbranch_scc1 L_more
    s_waitcnt lgkmcnt(3)
    buffer_store_dwordx4 v[96:99], v8, s[32:35], s60 offen sc0 sc1
    s_waitcnt lgkmcnt(2)
    buffer_store_dwordx4 v[100:103], v8, s[32:35], s61 offen sc0 sc1
    s_waitcnt lgkmcnt(1)
    buffer_store_dwordx4 v[104:107], v8, s[32:35], s62 offen sc0 sc1
    s_waitcnt lgkmcnt(0)
    buffer_store_dwordx4 v[108:111], v8, s[32:35], s63 offen sc0 sc1
    s_branch L_cdone
L_more:
    s_and_b32 s48, s42, s38
    s_add_u32 s44, s44, s48
    s_and_b32 s44, s44, s51
    s_mov_b32 s36, s37
    s_mov_b32 s37, 0
    s_and_b32 s39, s36, 0xfff
    s_bfe_u32 s40, s36, 0x9000c
    s_bfe_u32 s41, s36, 0x20015
    s_lshl_b32 s41, s41, 7
    s_add_u32 s41, s41, s39
    s_add_u32 s42, s40, 31
    s_lshr_b32 s42, s42, 5
    s_add_u32 s43, s39, s40
    s_lshl_b32 s43, s43, 12
    s_sub_u32 s43, s43, 3584
    s_mov_b32 s59, 2
    s_sub_u32 s48, s42, 1
    s_lshl_b32 s48, s48, 5
    s_sub_u32 s48, s40, s48
    v_sub_u32 v6, s48, v19
    v_cmp_lt_i32 s[64:65], 0, v6
    v_cmp_lt_i32 s[66:67], 4, v6
    s_waitcnt lgkmcnt(3)
    buffer_store_dwordx4 v[96:99], v8, s[32:35], s60 offen sc0 sc1
    v_cmp_lt_i32 s[68:69], 8, v6
    v_cmp_lt_i32 s[70:71], 12, v6
    v_cmp_lt_i32 s[72:73], 2, v6
    v_cmp_lt_i32 s[74:75], 6, v6
    v_cmp_lt_i32 s[76:77], 10, v6
    v_cmp_lt_i32 s[78:79], 14, v6
    v_and_b32 v12, 0xffff, v152
    v_mov_b64 v[144:145], 0
    v_mov_b64 v[146:147], 0
    v_mov_b64 v[148:149], 0
    v_mov_b64 v[150:151], 0
    v_cndmask_b32 v156, 0, v12, s[64:65]
    v_cndmask_b32 v157, 0, v12, s[68:69]
    v_cndmask_b32 v158, 0, v12, s[72:73]
    v_cndmask_b32 v159, 0, v12, s[76:77]
    v_cndmask_b32 v156, v156, v152, s[66:67]
    v_cndmask_b32 v157, v157, v152, s[70:71]
    v_cndmask_b32 v158, v158, v152, s[74:75]
    v_cndmask_b32 v159, v159, v152, s[78:79]
    v_mov_b64 v[192:193], 0
    v_mov_b64 v[194:195], 0
    v_mov_b64 v[196:197], 0
    s_waitcnt lgkmcnt(2)
    buffer_store_dwordx4 v[100:103], v8, s[32:35], s61 offen sc0 sc1
    v_mov_b64 v[198:199], 0
    v_mov_b64 v[200:201], 0
    v_mov_b64 v[202:203], 0
    v_mov_b64 v[204:205], 0
    v_mov_b64 v[206:207], 0
    v_mov_b64 v[208:209], 0
    v_mov_b64 v[210:211], 0
    v_mov_b64 v[212:213], 0
    v_mov_b64 v[214:215], 0
    v_mov_b64 v[216:217], 0
    v_mov_b64 v[218:219], 0
    v_mov_b64 v[220:221], 0
    v_mov_b64 v[222:223], 0
    v_mov_b64 v[224:225], 0
    v_mov_b64 v[226:227], 0
    v_mov_b64 v[228:229], 0
    v_mov_b64 v[230:231], 0
    v_mov_b64 v[232:233], 0
    v_mov_b64 v[234:235], 0
    v_mov_b64 v[236:237], 0
    v_mov_b64 v[238:239], 0
    v_mov_b64 v[240:241], 0
    s_waitcnt lgkmcnt(1)
    buffer_store_dwordx4 v[104:107], v8, s[32:35], s62 offen sc0 sc1
    v_mov_b64 v[242:243], 0
    v_mov_b64 v[244:245], 0
    v_mov_b64 v[246:247], 0
    v_mov_b64 v[248:249], 0
    v_mov_b64 v[250:251], 0
    v_mov_b64 v[252:253], 0
    v_mov_b64 v[254:255], 0
    s_mul_i32 s45, s44, 33792
    s_add_u32 s48, s45, 16896
    s_add_u32 s44, s44, 1
    s_and_b32 s44, s44, s51
    s_mul_i32 s49, s44, 33792
    s_cmp_eq_u32 s100, 0
    s_cselect_b32 s45, s48, s45
    s_cselect_b32 s48, s49, s48
    s_addc_u32 s44, s44, 0
    s_and_b32 s44, s44, s51
    s_mul_i32 s49, s57, 8448
    s_add_u32 s48, s48, s49
    v_add_u32 v5, s48, v3
    v_add_u32 v1, s45, v3
    s_mul_i32 s45, s44, 33792
    v_add_u32 v2, s45, v4
    s_sub_u32 s46, s42, 2
    s_waitcnt lgkmcnt(0)
    buffer_store_dwordx4 v[108:111], v8, s[32:35], s63 offen sc0 sc1
    s_mov_b32 s34, s43
    s_lshl_b32 s48, s57, 5
    s_add_u32 s48, s48, s41
    s_lshl_b32 s60, s48, 12
    s_add_u32 s61, s60, 65536
    s_add_u32 s62, s60, 69632
    s_add_u32 s63, s60, 4096
    s_branch L_cround
L_idle:
    s_or_b32 s48, s37, s58
    s_cbranch_scc0 L_fin
    s_cmp_eq_u32 s37, 0
    s_cbranch_scc1 L_busy
    s_mov_b32 s46, s42
L_idle1:
    s_barrier
    s_sub_u32 s46, s46, 1
    s_cmp_lg_u32 s46, 0
    s_cbranch_scc1 L_idle1
    s_lshr_b32 s48, s42, 1
    s_add_u32 s44, s44, s48
    s_and_b32 s44, s44, s51
    s_and_b32 s48, s42, s38
    s_add_u32 s44, s44, s48
    s_and_b32 s44, s44, s51
    s_mov_b32 s36, s37
    s_mov_b32 s37, 0
    s_and_b32 s39, s36, 0xfff
    s_bfe_u32 s40, s36, 0x9000c
    s_bfe_u32 s41, s36, 0x20015
    s_lshl_b32 s41, s41, 7
    s_add_u32 s41, s41, s39
    s_add_u32 s42, s40, 31
    s_lshr_b32 s42, s42, 5
    s_add_u32 s43, s39, s40
    s_lshl_b32 s43, s43, 12
    s_sub_u32 s43, s43, 3584
    s_mov_b32 s59, 2
    s_mov_b32 s34, s43
    s_lshl_b32 s48, s57, 5
    s_add_u32 s48, s48, s41
    s_lshl_b32 s60, s48, 12
    s_add_u32 s61, s60, 65536
    s_add_u32 s62, s60, 69632
    s_add_u32 s63, s60, 4096
    s_sub_u32 s48, s42, 1
    s_lshl_b32 s48, s48, 5
    s_sub_u32 s48, s40, s48
    v_sub_u32 v6, s48, v19
    v_cmp_lt_i32 s[64:65], 0, v6
    v_cmp_lt_i32 s[66:67], 4, v6
    v_cmp_lt_i32 s[68:69], 8, v6
    v_cmp_lt_i32 s[70:71], 12, v6
    v_cmp_lt_i32 s[72:73], 2, v6
    v_cmp_lt_i32 s[74:75], 6, v6
    v_cmp_lt_i32 s[76:77], 10, v6
    v_cmp_lt_i32 s[78:79], 14, v6
    v_and_b32 v12, 0xffff, v152
    v_mov_b64 v[144:145], 0
    v_mov_b64 v[146:147], 0
    v_mov_b64 v[148:149], 0
    v_mov_b64 v[150:151], 0
    v_cndmask_b32 v156, 0, v12, s[64:65]
    v_cndmask_b32 v157, 0, v12, s[68:69]
    v_cndmask_b32 v158, 0, v12, s[72:73]
    v_cndmask_b32 v159, 0, v12, s[76:77]
    v_cndmask_b32 v156, v156, v152, s[66:67]
    v_cndmask_b32 v157, v157, v152, s[70:71]
    v_cndmask_b32 v158, v158, v152, s[74:75]
    v_cndmask_b32 v159, v159, v152, s[78:79]
    v_mov_b64 v[192:193], 0
    v_mov_b64 v[194:195], 0
    v_mov_b64 v[196:197], 0
    v_mov_b64 v[198:199], 0
    v_mov_b64 v[200:201], 0
    v_mov_b64 v[202:203], 0
    v_mov_b64 v[204:205], 0
    v_mov_b64 v[206:207], 0
    v_mov_b64 v[208:209], 0
    v_mov_b64 v[210:211], 0
    v_mov_b64 v[212:213], 0
    v_mov_b64 v[214:215], 0
    v_mov_b64 v[216:217], 0
    v_mov_b64 v[218:219], 0
    v_mov_b64 v[220:221], 0
    v_mov_b64 v[222:223], 0
    v_mov_b64 v[224:225], 0
    v_mov_b64 v[226:227], 0
    v_mov_b64 v[228:229], 0
    v_mov_b64 v[230:231], 0
    v_mov_b64 v[232:233], 0
    v_mov_b64 v[234:235], 0
    v_mov_b64 v[236:237], 0
    v_mov_b64 v[238:239], 0
    v_mov_b64 v[240:241], 0
    v_mov_b64 v[242:243], 0
    v_mov_b64 v[244:245], 0
    v_mov_b64 v[246:247], 0
    v_mov_b64 v[248:249], 0
    v_mov_b64 v[250:251], 0
    v_mov_b64 v[252:253], 0
    v_mov_b64 v[254:255], 0
    s_mul_i32 s45, s44, 33792
    s_add_u32 s48, s45, 16896
    s_add_u32 s44, s44, 1
    s_and_b32 s44, s44, s51
    s_mul_i32 s49, s44, 33792
    s_cmp_eq_u32 s100, 0
    s_cselect_b32 s45, s48, s45
    s_cselect_b32 s48, s49, s48
    s_addc_u32 s44, s44, 0
    s_and_b32 s44, s44, s51
    s_mul_i32 s49, s57, 8448
    s_add_u32 s48, s48, s49
    v_add_u32 v5, s48, v3
    v_add_u32 v1, s45, v3
    s_mul_i32 s45, s44, 33792
    v_add_u32 v2, s45, v4
    s_sub_u32 s46, s42, 2
    s_branch L_cround
L_cdone:
    s_barrier
    s_cmp_lg_u32 s58, 0
    s_cbranch_scc1 L_slow
L_fin:
L_end:
    s_endpgm
L_slow:
    s_add_u32 s20, s4, s19
    s_addc_u32 s21, s5, 0
    s_mov_b32 s23, 0x20000
    s_add_u32 s24, s6, s19
    s_addc_u32 s25, s7, 0
    s_mov_b32 s27, 0x20000
    s_add_u32 s28, s8, s19
    s_addc_u32 s29, s9, 0
    s_mov_b32 s31, 0x20000
    s_lshl_b32 s48, s18, 15
    v_subrev_u32 v18, s48, v28
    v_mov_b32 v20, 0xff800000
    s_mul_i32 s44, s18, 33792
    s_lshr_b32 s48, s18, 1
    s_mul_i32 s48, s48, s38
    s_mul_i32 s49, s48, 67584
    s_sub_i32 s48, s44, s49
    v_add_u32 v1, s48, v3
    v_add_u32 v2, s48, v4
    s_mov_b32 s36, s96
    s_bitcmp1_b32 s58, 0
    s_cbranch_scc1 L_sround
L_snext:
    s_bitcmp1_b32 s58, 1
    s_cbranch_scc0 L_fin
    s_mov_b32 s58, 0
    s_mov_b32 s36, s97
L_sround:
    s_and_b32 s39, s36, 0xfff
    s_bfe_u32 s40, s36, 0x9000c
    s_bfe_u32 s41, s36, 0x20015
    s_lshl_b32 s41, s41, 7
    s_add_u32 s41, s41, s39
    s_add_u32 s42, s40, 31
    s_lshr_b32 s42, s42, 5
    s_add_u32 s43, s39, s40
    s_lshl_b32 s43, s43, 12
    s_sub_u32 s43, s43, 3584
    s_mov_b32 s22, s43
    s_mov_b32 s26, s43
    s_mov_b32 s30, s43
    s_mov_b32 s34, s43
    s_lshl_b32 s48, s57, 5
    s_add_u32 s48, s48, s41
    s_lshl_b32 s60, s48, 12
    s_add_u32 s61, s60, 65536
    s_add_u32 s62, s60, 69632
    s_add_u32 s63, s60, 4096
    s_sub_u32 s48, s42, 1
    s_lshl_b32 s48, s48, 5
    s_sub_u32 s48, s40, s48
    v_sub_u32 v6, s48, v19
    v_cmp_lt_i32 s[64:65], 0, v6
    v_cmp_lt_i32 s[66:67], 4, v6
    v_cmp_lt_i32 s[68:69], 8, v6
    v_cmp_lt_i32 s[70:71], 12, v6
    v_cmp_lt_i32 s[72:73], 2, v6
    v_cmp_lt_i32 s[74:75], 6, v6
    v_cmp_lt_i32 s[76:77], 10, v6
    v_cmp_lt_i32 s[78:79], 14, v6
    v_and_b32 v12, 0xffff, v152
    v_mov_b64 v[144:145], 0
    v_mov_b64 v[146:147], 0
    v_mov_b64 v[148:149], 0
    v_mov_b64 v[150:151], 0
    v_cndmask_b32 v156, 0, v12, s[64:65]
    v_cndmask_b32 v157, 0, v12, s[68:69]
    v_cndmask_b32 v158, 0, v12, s[72:73]
    v_cndmask_b32 v159, 0, v12, s[76:77]
    v_cndmask_b32 v156, v156, v152, s[66:67]
    v_cndmask_b32 v157, v157, v152, s[70:71]
    v_cndmask_b32 v158, v158, v152, s[74:75]
    v_cndmask_b32 v159, v159, v152, s[78:79]
    v_mov_b64 v[192:193], 0
    v_mov_b64 v[194:195], 0
    v_mov_b64 v[196:197], 0
    v_mov_b64 v[198:199], 0
    v_mov_b64 v[200:201], 0
    v_mov_b64 v[202:203], 0
    v_mov_b64 v[204:205], 0
    v_mov_b64 v[206:207], 0
    v_mov_b64 v[208:209], 0
    v_mov_b64 v[210:211], 0
    v_mov_b64 v[212:213], 0
    v_mov_b64 v[214:215], 0
    v_mov_b64 v[216:217], 0
    v_mov_b64 v[218:219], 0
    v_mov_b64 v[220:221], 0
    v_mov_b64 v[222:223], 0
    v_mov_b64 v[224:225], 0
    v_mov_b64 v[226:227], 0
    v_mov_b64 v[228:229], 0
    v_mov_b64 v[230:231], 0
    v_mov_b64 v[232:233], 0
    v_mov_b64 v[234:235], 0
    v_mov_b64 v[236:237], 0
    v_mov_b64 v[238:239], 0
    v_mov_b64 v[240:241], 0
    v_mov_b64 v[242:243], 0
    v_mov_b64 v[244:245], 0
    v_mov_b64 v[246:247], 0
    v_mov_b64 v[248:249], 0
    v_mov_b64 v[250:251], 0
    v_mov_b64 v[252:253], 0
    v_mov_b64 v[254:255], 0
    s_add_u32 s48, s44, 0
    s_mov_b32 m0, s48
    s_add_u32 s49, s60, 0
    buffer_load_dwordx4 v18, s[20:23], s49 offen lds
    s_add_u32 s48, s44, 1056
    s_mov_b32 m0, s48
    s_add_u32 s49, s60, 16384
    buffer_load_dwordx4 v18, s[20:23], s49 offen lds
    s_add_u32 s48, s44, 2112
    s_mov_b32 m0, s48
    s_add_u32 s49, s60, 32768
    buffer_load_dwordx4 v18, s[20:23], s49 offen lds
    s_add_u32 s48, s44, 3168
    s_mov_b32 m0, s48
    s_add_u32 s49, s60, 49152
    buffer_load_dwordx4 v18, s[20:23], s49 offen lds
    s_add_u32 s48, s44, 4224
    s_mov_b32 m0, s48
    s_add_u32 s49, s60, 65536
    buffer_load_dwordx4 v18, s[20:23], s49 offen lds
    s_add_u32 s48, s44, 5280
    s_mov_b32 m0, s48
    s_add_u32 s49, s60, 81920
    buffer_load_dwordx4 v18, s[20:23], s49 offen lds
    s_add_u32 s48, s44, 6336
    s_mov_b32 m0, s48
    s_add_u32 s49, s60, 98304
    buffer_load_dwordx4 v18, s[20:23], s49 offen lds
    s_add_u32 s48, s44, 7392
    s_mov_b32 m0, s48
    s_add_u32 s49, s60, 114688
    buffer_load_dwordx4 v18, s[20:23], s49 offen lds
    s_waitcnt vmcnt(0)
    ds_read_b128 v[112:115], v1 offset:0
    ds_read_b128 v[116:119], v1 offset:64
    ds_read_b128 v[120:123], v1 offset:128
    ds_read_b128 v[124:127], v1 offset:192
    ds_read_b128 v[128:131], v1 offset:512
    ds_read_b128 v[132:135], v1 offset:576
    ds_read_b128 v[136:139], v1 offset:640
    ds_read_b128 v[140:143], v1 offset:704
    s_waitcnt lgkmcnt(0)
    v_lshlrev_b32 v32, 16, v112
    v_and_b32 v33, 0xffff0000, v112
    v_mul_f32 v32, s50, v32
    v_mul_f32 v33, s50, v33
    v_cvt_pk_bf16_f32 v112, v32, v33
    v_lshlrev_b32 v34, 16, v113
    v_and_b32 v35, 0xffff0000, v113
    v_mul_f32 v34, s50, v34
    v_mul_f32 v35, s50, v35
    v_cvt_pk_bf16_f32 v113, v34, v35
    v_lshlrev_b32 v36, 16, v114
    v_and_b32 v37, 0xffff0000, v114
    v_mul_f32 v36, s50, v36
    v_mul_f32 v37, s50, v37
    v_cvt_pk_bf16_f32 v114, v36, v37
    v_lshlrev_b32 v38, 16, v115
    v_and_b32 v39, 0xffff0000, v115
    v_mul_f32 v38, s50, v38
    v_mul_f32 v39, s50, v39
    v_cvt_pk_bf16_f32 v115, v38, v39
    v_lshlrev_b32 v32, 16, v116
    v_and_b32 v33, 0xffff0000, v116
    v_mul_f32 v32, s50, v32
    v_mul_f32 v33, s50, v33
    v_cvt_pk_bf16_f32 v116, v32, v33
    v_lshlrev_b32 v34, 16, v117
    v_and_b32 v35, 0xffff0000, v117
    v_mul_f32 v34, s50, v34
    v_mul_f32 v35, s50, v35
    v_cvt_pk_bf16_f32 v117, v34, v35
    v_lshlrev_b32 v36, 16, v118
    v_and_b32 v37, 0xffff0000, v118
    v_mul_f32 v36, s50, v36
    v_mul_f32 v37, s50, v37
    v_cvt_pk_bf16_f32 v118, v36, v37
    v_lshlrev_b32 v38, 16, v119
    v_and_b32 v39, 0xffff0000, v119
    v_mul_f32 v38, s50, v38
    v_mul_f32 v39, s50, v39
    v_cvt_pk_bf16_f32 v119, v38, v39
    v_lshlrev_b32 v32, 16, v120
    v_and_b32 v33, 0xffff0000, v120
    v_mul_f32 v32, s50, v32
    v_mul_f32 v33, s50, v33
    v_cvt_pk_bf16_f32 v120, v32, v33
    v_lshlrev_b32 v34, 16, v121
    v_and_b32 v35, 0xffff0000, v121
    v_mul_f32 v34, s50, v34
    v_mul_f32 v35, s50, v35
    v_cvt_pk_bf16_f32 v121, v34, v35
    v_lshlrev_b32 v36, 16, v122
    v_and_b32 v37, 0xffff0000, v122
    v_mul_f32 v36, s50, v36
    v_mul_f32 v37, s50, v37
    v_cvt_pk_bf16_f32 v122, v36, v37
    v_lshlrev_b32 v38, 16, v123
    v_and_b32 v39, 0xffff0000, v123
    v_mul_f32 v38, s50, v38
    v_mul_f32 v39, s50, v39
    v_cvt_pk_bf16_f32 v123, v38, v39
    v_lshlrev_b32 v32, 16, v124
    v_and_b32 v33, 0xffff0000, v124
    v_mul_f32 v32, s50, v32
    v_mul_f32 v33, s50, v33
    v_cvt_pk_bf16_f32 v124, v32, v33
    v_lshlrev_b32 v34, 16, v125
    v_and_b32 v35, 0xffff0000, v125
    v_mul_f32 v34, s50, v34
    v_mul_f32 v35, s50, v35
    v_cvt_pk_bf16_f32 v125, v34, v35
    v_lshlrev_b32 v36, 16, v126
    v_and_b32 v37, 0xffff0000, v126
    v_mul_f32 v36, s50, v36
    v_mul_f32 v37, s50, v37
    v_cvt_pk_bf16_f32 v126, v36, v37
    v_lshlrev_b32 v38, 16, v127
    v_and_b32 v39, 0xffff0000, v127
    v_mul_f32 v38, s50, v38
    v_mul_f32 v39, s50, v39
    v_cvt_pk_bf16_f32 v127, v38, v39
    v_lshlrev_b32 v32, 16, v128
    v_and_b32 v33, 0xffff0000, v128
    v_mul_f32 v32, s50, v32
    v_mul_f32 v33, s50, v33
    v_cvt_pk_bf16_f32 v128, v32, v33
    v_lshlrev_b32 v34, 16, v129
    v_and_b32 v35, 0xffff0000, v129
    v_mul_f32 v34, s50, v34
    v_mul_f32 v35, s50, v35
    v_cvt_pk_bf16_f32 v129, v34, v35
    v_lshlrev_b32 v36, 16, v130
    v_and_b32 v37, 0xffff0000, v130
    v_mul_f32 v36, s50, v36
    v_mul_f32 v37, s50, v37
    v_cvt_pk_bf16_f32 v130, v36, v37
    v_lshlrev_b32 v38, 16, v131
    v_and_b32 v39, 0xffff0000, v131
    v_mul_f32 v38, s50, v38
    v_mul_f32 v39, s50, v39
    v_cvt_pk_bf16_f32 v131, v38, v39
    v_lshlrev_b32 v32, 16, v132
    v_and_b32 v33, 0xffff0000, v132
    v_mul_f32 v32, s50, v32
    v_mul_f32 v33, s50, v33
    v_cvt_pk_bf16_f32 v132, v32, v33
    v_lshlrev_b32 v34, 16, v133
    v_and_b32 v35, 0xffff0000, v133
    v_mul_f32 v34, s50, v34
    v_mul_f32 v35, s50, v35
    v_cvt_pk_bf16_f32 v133, v34, v35
    v_lshlrev_b32 v36, 16, v134
    v_and_b32 v37, 0xffff0000, v134
    v_mul_f32 v36, s50, v36
    v_mul_f32 v37, s50, v37
    v_cvt_pk_bf16_f32 v134, v36, v37
    v_lshlrev_b32 v38, 16, v135
    v_and_b32 v39, 0xffff0000, v135
    v_mul_f32 v38, s50, v38
    v_mul_f32 v39, s50, v39
    v_cvt_pk_bf16_f32 v135, v38, v39
    v_lshlrev_b32 v32, 16, v136
    v_and_b32 v33, 0xffff0000, v136
    v_mul_f32 v32, s50, v32
    v_mul_f32 v33, s50, v33
    v_cvt_pk_bf16_f32 v136, v32, v33
    v_lshlrev_b32 v34, 16, v137
    v_and_b32 v35, 0xffff0000, v137
    v_mul_f32 v34, s50, v34
    v_mul_f32 v35, s50, v35
    v_cvt_pk_bf16_f32 v137, v34, v35
    v_lshlrev_b32 v36, 16, v138
    v_and_b32 v37, 0xffff0000, v138
    v_mul_f32 v36, s50, v36
    v_mul_f32 v37, s50, v37
    v_cvt_pk_bf16_f32 v138, v36, v37
    v_lshlrev_b32 v38, 16, v139
    v_and_b32 v39, 0xffff0000, v139
    v_mul_f32 v38, s50, v38
    v_mul_f32 v39, s50, v39
    v_cvt_pk_bf16_f32 v139, v38, v39
    v_lshlrev_b32 v32, 16, v140
    v_and_b32 v33, 0xffff0000, v140
    v_mul_f32 v32, s50, v32
    v_mul_f32 v33, s50, v33
    v_cvt_pk_bf16_f32 v140, v32, v33
    v_lshlrev_b32 v34, 16, v141
    v_and_b32 v35, 0xffff0000, v141
    v_mul_f32 v34, s50, v34
    v_mul_f32 v35, s50, v35
    v_cvt_pk_bf16_f32 v141, v34, v35
    v_lshlrev_b32 v36, 16, v142
    v_and_b32 v37, 0xffff0000, v142
    v_mul_f32 v36, s50, v36
    v_mul_f32 v37, s50, v37
    v_cvt_pk_bf16_f32 v142, v36, v37
    v_lshlrev_b32 v38, 16, v143
    v_and_b32 v39, 0xffff0000, v143
    v_mul_f32 v38, s50, v38
    v_mul_f32 v39, s50, v39
    v_cvt_pk_bf16_f32 v143, v38, v39
    v_mov_b32 v14, 0xf149f2ca
    v_mov_b32 v15, 0xf149f2ca
    v_mov_b64 v[176:177], 0
    v_mov_b64 v[178:179], 0
    v_mov_b64 v[180:181], 0
    v_mov_b64 v[182:183], 0
    s_lshl_b32 s45, s39, 12
    s_mov_b32 s46, s42
L_stile:
    s_add_u32 s48, s44, 0
    s_mov_b32 m0, s48
    s_add_u32 s49, s45, 0
    buffer_load_dwordx4 v18, s[24:27], s49 offen lds
    s_add_u32 s48, s44, 1056
    s_mov_b32 m0, s48
    s_add_u32 s49, s45, 16384
    buffer_load_dwordx4 v18, s[24:27], s49 offen lds
    s_add_u32 s48, s44, 2112
    s_mov_b32 m0, s48
    s_add_u32 s49, s45, 32768
    buffer_load_dwordx4 v18, s[24:27], s49 offen lds
    s_add_u32 s48, s44, 3168
    s_mov_b32 m0, s48
    s_add_u32 s49, s45, 49152
    buffer_load_dwordx4 v18, s[24:27], s49 offen lds
    s_add_u32 s48, s44, 4224
    s_mov_b32 m0, s48
    s_add_u32 s49, s45, 65536
    buffer_load_dwordx4 v18, s[24:27], s49 offen lds
    s_add_u32 s48, s44, 5280
    s_mov_b32 m0, s48
    s_add_u32 s49, s45, 81920
    buffer_load_dwordx4 v18, s[24:27], s49 offen lds
    s_add_u32 s48, s44, 6336
    s_mov_b32 m0, s48
    s_add_u32 s49, s45, 98304
    buffer_load_dwordx4 v18, s[24:27], s49 offen lds
    s_add_u32 s48, s44, 7392
    s_mov_b32 m0, s48
    s_add_u32 s49, s45, 114688
    buffer_load_dwordx4 v18, s[24:27], s49 offen lds
    s_add_u32 s48, s44, 8448
    s_mov_b32 m0, s48
    s_add_u32 s49, s45, 0
    buffer_load_dwordx4 v18, s[28:31], s49 offen lds
    s_add_u32 s48, s44, 9504
    s_mov_b32 m0, s48
    s_add_u32 s49, s45, 16384
    buffer_load_dwordx4 v18, s[28:31], s49 offen lds
    s_add_u32 s48, s44, 10560
    s_mov_b32 m0, s48
    s_add_u32 s49, s45, 32768
    buffer_load_dwordx4 v18, s[28:31], s49 offen lds
    s_add_u32 s48, s44, 11616
    s_mov_b32 m0, s48
    s_add_u32 s49, s45, 49152
    buffer_load_dwordx4 v18, s[28:31], s49 offen lds
    s_add_u32 s48, s44, 12672
    s_mov_b32 m0, s48
    s_add_u32 s49, s45, 65536
    buffer_load_dwordx4 v18, s[28:31], s49 offen lds
    s_add_u32 s48, s44, 13728
    s_mov_b32 m0, s48
    s_add_u32 s49, s45, 81920
    buffer_load_dwordx4 v18, s[28:31], s49 offen lds
    s_add_u32 s48, s44, 14784
    s_mov_b32 m0, s48
    s_add_u32 s49, s45, 98304
    buffer_load_dwordx4 v18, s[28:31], s49 offen lds
    s_add_u32 s48, s44, 15840
    s_mov_b32 m0, s48
    s_add_u32 s49, s45, 114688
    buffer_load_dwordx4 v18, s[28:31], s49 offen lds
    s_cmp_lg_u32 s46, 1
    s_cbranch_scc1 L_snomask
    v_cndmask_b32 v176, v20, 0, s[64:65]
    v_cndmask_b32 v177, v20, 0, s[66:67]
    v_cndmask_b32 v178, v20, 0, s[68:69]
    v_cndmask_b32 v179, v20, 0, s[70:71]
    v_cndmask_b32 v180, v20, 0, s[72:73]
    v_cndmask_b32 v181, v20, 0, s[74:75]
    v_cndmask_b32 v182, v20, 0, s[76:77]
    v_cndmask_b32 v183, v20, 0, s[78:79]
L_snomask:
    s_waitcnt vmcnt(0)
    ds_read_b128 v[80:83], v1 offset:0
    ds_read_b128 v[84:87], v1 offset:512
    ds_read_b128 v[88:91], v1 offset:64
    ds_read_b128 v[92:95], v1 offset:576
    ds_read_b128 v[96:99], v1 offset:128
    ds_read_b128 v[100:103], v1 offset:640
    ds_read_b128 v[104:107], v1 offset:192
    ds_read_b128 v[108:111], v1 offset:704
    s_waitcnt lgkmcnt(0)
    ds_read_b64_tr_b16 v[48:49], v2 offset:8448
    ds_read_b64_tr_b16 v[50:51], v2 offset:8960
    ds_read_b64_tr_b16 v[52:53], v2 offset:8480
    ds_read_b64_tr_b16 v[54:55], v2 offset:8992
    ds_read_b64_tr_b16 v[56:57], v2 offset:8512
    ds_read_b64_tr_b16 v[58:59], v2 offset:9024
    ds_read_b64_tr_b16 v[60:61], v2 offset:8544
    ds_read_b64_tr_b16 v[62:63], v2 offset:9056
    v_mfma_f32_16x16x32_bf16 v[160:163], v[80:83], v[112:115], v[176:179]
    v_mfma_f32_16x16x32_bf16 v[168:171], v[80:83], v[128:131], v[176:179]
    v_mfma_f32_16x16x32_bf16 v[164:167], v[84:87], v[112:115], v[180:183]
    v_mfma_f32_16x16x32_bf16 v[172:175], v[84:87], v[128:131], v[180:183]
    v_mfma_f32_16x16x32_bf16 v[160:163], v[88:91], v[116:119], v[160:163]
    v_mfma_f32_16x16x32_bf16 v[168:171], v[88:91], v[132:135], v[168:171]
    v_mfma_f32_16x16x32_bf16 v[164:167], v[92:95], v[116:119], v[164:167]
    v_mfma_f32_16x16x32_bf16 v[172:175], v[92:95], v[132:135], v[172:175]
    v_mfma_f32_16x16x32_bf16 v[160:163], v[96:99], v[120:123], v[160:163]
    v_mfma_f32_16x16x32_bf16 v[168:171], v[96:99], v[136:139], v[168:171]
    v_mfma_f32_16x16x32_bf16 v[164:167], v[100:103], v[120:123], v[164:167]
    v_mfma_f32_16x16x32_bf16 v[172:175], v[100:103], v[136:139], v[172:175]
    v_mfma_f32_16x16x32_bf16 v[160:163], v[104:107], v[124:127], v[160:163]
    v_mfma_f32_16x16x32_bf16 v[168:171], v[104:107], v[140:143], v[168:171]
    v_mfma_f32_16x16x32_bf16 v[164:167], v[108:111], v[124:127], v[164:167]
    v_mfma_f32_16x16x32_bf16 v[172:175], v[108:111], v[140:143], v[172:175]
    ds_read_b64_tr_b16 v[64:65], v2 offset:8576
    ds_read_b64_tr_b16 v[66:67], v2 offset:9088
    ds_read_b64_tr_b16 v[68:69], v2 offset:8608
    ds_read_b64_tr_b16 v[70:71], v2 offset:9120
    ds_read_b64_tr_b16 v[72:73], v2 offset:8640
    ds_read_b64_tr_b16 v[74:75], v2 offset:9152
    ds_read_b64_tr_b16 v[76:77], v2 offset:8672
    ds_read_b64_tr_b16 v[78:79], v2 offset:9184
    s_nop 7
    v_max3_f32 v12, v14, v160, v161
    v_max3_f32 v12, v12, v162, v163
    v_max3_f32 v12, v12, v164, v165
    v_max3_f32 v12, v12, v166, v167
    v_mov_b32 v13, v12
    s_nop 1
    v_permlane16_swap_b32 v12, v13
    v_max_f32 v12, v12, v13
    v_mov_b32 v13, v12
    s_nop 1
    v_permlane32_swap_b32 v12, v13
    v_max_f32 v12, v12, v13
    v_sub_f32 v16, v14, v12
    v_exp_f32 v16, v16
    v_mov_b32 v14, v12
    v_sub_f32 v160, v160, v12
    v_sub_f32 v161, v161, v12
    v_sub_f32 v162, v162, v12
    v_sub_f32 v163, v163, v12
    v_sub_f32 v164, v164, v12
    v_sub_f32 v165, v165, v12
    v_sub_f32 v166, v166, v12
    v_sub_f32 v167, v167, v12
    v_exp_f32 v160, v160
    v_exp_f32 v161, v161
    v_exp_f32 v162, v162
    v_exp_f32 v163, v163
    v_exp_f32 v164, v164
    v_exp_f32 v165, v165
    v_exp_f32 v166, v166
    v_exp_f32 v167, v167
    v_pk_mul_f32 v[192:193], v[192:193], v[16:17] op_sel_hi:[1,0]
    v_pk_mul_f32 v[194:195], v[194:195], v[16:17] op_sel_hi:[1,0]
    v_pk_mul_f32 v[196:197], v[196:197], v[16:17] op_sel_hi:[1,0]
    v_pk_mul_f32 v[198:199], v[198:199], v[16:17] op_sel_hi:[1,0]
    v_pk_mul_f32 v[200:201], v[200:201], v[16:17] op_sel_hi:[1,0]
    v_pk_mul_f32 v[202:203], v[202:203], v[16:17] op_sel_hi:[1,0]
    v_pk_mul_f32 v[204:205], v[204:205], v[16:17] op_sel_hi:[1,0]
    v_pk_mul_f32 v[206:207], v[206:207], v[16:17] op_sel_hi:[1,0]
    v_pk_mul_f32 v[208:209], v[208:209], v[16:17] op_sel_hi:[1,0]
    v_pk_mul_f32 v[210:211], v[210:211], v[16:17] op_sel_hi:[1,0]
    v_pk_mul_f32 v[212:213], v[212:213], v[16:17] op_sel_hi:[1,0]
    v_pk_mul_f32 v[214:215], v[214:215], v[16:17] op_sel_hi:[1,0]
    v_pk_mul_f32 v[216:217], v[216:217], v[16:17] op_sel_hi:[1,0]
    v_pk_mul_f32 v[218:219], v[218:219], v[16:17] op_sel_hi:[1,0]
    v_pk_mul_f32 v[220:221], v[220:221], v[16:17] op_sel_hi:[1,0]
    v_pk_mul_f32 v[222:223], v[222:223], v[16:17] op_sel_hi:[1,0]
    v_pk_mul_f32 v[144:145], v[144:145], v[16:17] op_sel_hi:[1,0]
    v_pk_mul_f32 v[146:147], v[146:147], v[16:17] op_sel_hi:[1,0]
    v_max3_f32 v12, v15, v168, v169
    v_max3_f32 v12, v12, v170, v171
    v_max3_f32 v12, v12, v172, v173
    v_max3_f32 v12, v12, v174, v175
    v_mov_b32 v13, v12
    s_nop 1
    v_permlane16_swap_b32 v12, v13
    v_max_f32 v12, v12, v13
    v_mov_b32 v13, v12
    s_nop 1
    v_permlane32_swap_b32 v12, v13
    v_max_f32 v12, v12, v13
    v_sub_f32 v16, v15, v12
    v_exp_f32 v16, v16
    v_mov_b32 v15, v12
    v_sub_f32 v168, v168, v12
    v_sub_f32 v169, v169, v12
    v_sub_f32 v170, v170, v12
    v_sub_f32 v171, v171, v12
    v_sub_f32 v172, v172, v12
    v_sub_f32 v173, v173, v12
    v_sub_f32 v174, v174, v12
    v_sub_f32 v175, v175, v12
    v_exp_f32 v168, v168
    v_exp_f32 v169, v169
    v_exp_f32 v170, v170
    v_exp_f32 v171, v171
    v_exp_f32 v172, v172
    v_exp_f32 v173, v173
    v_exp_f32 v174, v174
    v_exp_f32 v175, v175
    v_pk_mul_f32 v[224:225], v[224:225], v[16:17] op_sel_hi:[1,0]
    v_pk_mul_f32 v[226:227], v[226:227], v[16:17] op_sel_hi:[1,0]
    v_pk_mul_f32 v[228:229], v[228:229], v[16:17] op_sel_hi:[1,0]
    v_pk_mul_f32 v[230:231], v[230:231], v[16:17] op_sel_hi:[1,0]
    v_pk_mul_f32 v[232:233], v[232:233], v[16:17] op_sel_hi:[1,0]
    v_pk_mul_f32 v[234:235], v[234:235], v[16:17] op_sel_hi:[1,0]
    v_pk_mul_f32 v[236:237], v[236:237], v[16:17] op_sel_hi:[1,0]
    v_pk_mul_f32 v[238:239], v[238:239], v[16:17] op_sel_hi:[1,0]
    v_pk_mul_f32 v[240:241], v[240:241], v[16:17] op_sel_hi:[1,0]
    v_pk_mul_f32 v[242:243], v[242:243], v[16:17] op_sel_hi:[1,0]
    v_pk_mul_f32 v[244:245], v[244:245], v[16:17] op_sel_hi:[1,0]
    v_pk_mul_f32 v[246:247], v[246:247], v[16:17] op_sel_hi:[1,0]
    v_pk_mul_f32 v[248:249], v[248:249], v[16:17] op_sel_hi:[1,0]
    v_pk_mul_f32 v[250:251], v[250:251], v[16:17] op_sel_hi:[1,0]
    v_pk_mul_f32 v[252:253], v[252:253], v[16:17] op_sel_hi:[1,0]
    v_pk_mul_f32 v[254:255], v[254:255], v[16:17] op_sel_hi:[1,0]
    v_pk_mul_f32 v[148:149], v[148:149], v[16:17] op_sel_hi:[1,0]
    v_pk_mul_f32 v[150:151], v[150:151], v[16:17] op_sel_hi:[1,0]
    v_cvt_pk_bf16_f32 v40, v160, v161
    v_cvt_pk_bf16_f32 v41, v162, v163
    v_cvt_pk_bf16_f32 v42, v164, v165
    v_cvt_pk_bf16_f32 v43, v166, v167
    v_cvt_pk_bf16_f32 v44, v168, v169
    v_cvt_pk_bf16_f32 v45, v170, v171
    v_cvt_pk_bf16_f32 v46, v172, v173
    v_cvt_pk_bf16_f32 v47, v174, v175
    s_waitcnt lgkmcnt(0)
    s_nop 0
    v_mfma_f32_16x16x32_bf16 v[144:147], v[152:155], v[40:43], v[144:147]
    v_mfma_f32_16x16x32_bf16 v[192:195], v[48:51], v[40:43], v[192:195]
    v_mfma_f32_16x16x32_bf16 v[196:199], v[52:55], v[40:43], v[196:199]
    v_mfma_f32_16x16x32_bf16 v[200:203], v[56:59], v[40:43], v[200:203]
    v_mfma_f32_16x16x32_bf16 v[204:207], v[60:63], v[40:43], v[204:207]
    v_mfma_f32_16x16x32_bf16 v[208:211], v[64:67], v[40:43], v[208:211]
    v_mfma_f32_16x16x32_bf16 v[212:215], v[68:71], v[40:43], v[212:215]
    v_mfma_f32_16x16x32_bf16 v[216:219], v[72:75], v[40:43], v[216:219]
    v_mfma_f32_16x16x32_bf16 v[220:223], v[76:79], v[40:43], v[220:223]
    v_mfma_f32_16x16x32_bf16 v[148:151], v[152:155], v[44:47], v[148:151]
    v_mfma_f32_16x16x32_bf16 v[224:227], v[48:51], v[44:47], v[224:227]
    v_mfma_f32_16x16x32_bf16 v[228:231], v[52:55], v[44:47], v[228:231]
    v_mfma_f32_16x16x32_bf16 v[232:235], v[56:59], v[44:47], v[232:235]
    v_mfma_f32_16x16x32_bf16 v[236:239], v[60:63], v[44:47], v[236:239]
    v_mfma_f32_16x16x32_bf16 v[240:243], v[64:67], v[44:47], v[240:243]
    v_mfma_f32_16x16x32_bf16 v[244:247], v[68:71], v[44:47], v[244:247]
    v_mfma_f32_16x16x32_bf16 v[248:251], v[72:75], v[44:47], v[248:251]
    v_mfma_f32_16x16x32_bf16 v[252:255], v[76:79], v[44:47], v[252:255]
    s_add_u32 s45, s45, 131072
    s_sub_u32 s46, s46, 1
    s_cmp_lg_u32 s46, 0
    s_nop 7
    s_cbranch_scc1 L_stile
    v_rcp_f32 v16, v144
    v_rcp_f32 v17, v148
    s_nop 0
    v_pk_mul_f32 v[192:193], v[192:193], v[16:17] op_sel_hi:[1,0]
    v_pk_mul_f32 v[194:195], v[194:195], v[16:17] op_sel_hi:[1,0]
    v_cvt_pk_bf16_f32 v112, v192, v193
    v_cvt_pk_bf16_f32 v113, v194, v195
    v_pk_mul_f32 v[196:197], v[196:197], v[16:17] op_sel_hi:[1,0]
    v_pk_mul_f32 v[198:199], v[198:199], v[16:17] op_sel_hi:[1,0]
    v_cvt_pk_bf16_f32 v114, v196, v197
    v_cvt_pk_bf16_f32 v115, v198, v199
    ds_write2_b64 v9, v[112:113], v[114:115] offset0:0 offset1:4
    v_pk_mul_f32 v[200:201], v[200:201], v[16:17] op_sel_hi:[1,0]
    v_pk_mul_f32 v[202:203], v[202:203], v[16:17] op_sel_hi:[1,0]
    v_cvt_pk_bf16_f32 v116, v200, v201
    v_cvt_pk_bf16_f32 v117, v202, v203
    v_pk_mul_f32 v[204:205], v[204:205], v[16:17] op_sel_hi:[1,0]
    v_pk_mul_f32 v[206:207], v[206:207], v[16:17] op_sel_hi:[1,0]
    v_cvt_pk_bf16_f32 v118, v204, v205
    v_cvt_pk_bf16_f32 v119, v206, v207
    ds_write2_b64 v9, v[116:117], v[118:119] offset0:8 offset1:12
    v_pk_mul_f32 v[208:209], v[208:209], v[16:17] op_sel_hi:[1,0]
    v_pk_mul_f32 v[210:211], v[210:211], v[16:17] op_sel_hi:[1,0]
    v_cvt_pk_bf16_f32 v120, v208, v209
    v_cvt_pk_bf16_f32 v121, v210, v211
    v_pk_mul_f32 v[212:213], v[212:213], v[16:17] op_sel_hi:[1,0]
    v_pk_mul_f32 v[214:215], v[214:215], v[16:17] op_sel_hi:[1,0]
    v_cvt_pk_bf16_f32 v122, v212, v213
    v_cvt_pk_bf16_f32 v123, v214, v215
    ds_write2_b64 v9, v[120:121], v[122:123] offset0:16 offset1:20
    v_pk_mul_f32 v[216:217], v[216:217], v[16:17] op_sel_hi:[1,0]
    v_pk_mul_f32 v[218:219], v[218:219], v[16:17] op_sel_hi:[1,0]
    v_cvt_pk_bf16_f32 v124, v216, v217
    v_cvt_pk_bf16_f32 v125, v218, v219
    v_pk_mul_f32 v[220:221], v[220:221], v[16:17] op_sel_hi:[1,0]
    v_pk_mul_f32 v[222:223], v[222:223], v[16:17] op_sel_hi:[1,0]
    v_cvt_pk_bf16_f32 v126, v220, v221
    v_cvt_pk_bf16_f32 v127, v222, v223
    ds_write2_b64 v9, v[124:125], v[126:127] offset0:24 offset1:28
    ds_read_b128 v[80:83], v11 offset:0
    ds_read_b128 v[84:87], v11 offset:1088
    ds_read_b128 v[88:91], v11 offset:2176
    ds_read_b128 v[92:95], v11 offset:3264
    v_pk_mul_f32 v[224:225], v[224:225], v[16:17] op_sel:[0,1]
    v_pk_mul_f32 v[226:227], v[226:227], v[16:17] op_sel:[0,1]
    v_cvt_pk_bf16_f32 v128, v224, v225
    v_cvt_pk_bf16_f32 v129, v226, v227
    s_waitcnt lgkmcnt(3)
    buffer_store_dwordx4 v[80:83], v7, s[32:35], s60 offen sc0 sc1
    v_pk_mul_f32 v[228:229], v[228:229], v[16:17] op_sel:[0,1]
    v_pk_mul_f32 v[230:231], v[230:231], v[16:17] op_sel:[0,1]
    v_cvt_pk_bf16_f32 v130, v228, v229
    v_cvt_pk_bf16_f32 v131, v230, v231
    ds_write2_b64 v9, v[128:129], v[130:131] offset0:0 offset1:4
    s_waitcnt lgkmcnt(3)
    buffer_store_dwordx4 v[84:87], v7, s[32:35], s61 offen sc0 sc1
    v_pk_mul_f32 v[232:233], v[232:233], v[16:17] op_sel:[0,1]
    v_pk_mul_f32 v[234:235], v[234:235], v[16:17] op_sel:[0,1]
    v_cvt_pk_bf16_f32 v132, v232, v233
    v_cvt_pk_bf16_f32 v133, v234, v235
    v_pk_mul_f32 v[236:237], v[236:237], v[16:17] op_sel:[0,1]
    v_pk_mul_f32 v[238:239], v[238:239], v[16:17] op_sel:[0,1]
    v_cvt_pk_bf16_f32 v134, v236, v237
    v_cvt_pk_bf16_f32 v135, v238, v239
    ds_write2_b64 v9, v[132:133], v[134:135] offset0:8 offset1:12
    s_waitcnt lgkmcnt(3)
    buffer_store_dwordx4 v[88:91], v7, s[32:35], s62 offen sc0 sc1
    v_pk_mul_f32 v[240:241], v[240:241], v[16:17] op_sel:[0,1]
    v_pk_mul_f32 v[242:243], v[242:243], v[16:17] op_sel:[0,1]
    v_cvt_pk_bf16_f32 v136, v240, v241
    v_cvt_pk_bf16_f32 v137, v242, v243
    v_pk_mul_f32 v[244:245], v[244:245], v[16:17] op_sel:[0,1]
    v_pk_mul_f32 v[246:247], v[246:247], v[16:17] op_sel:[0,1]
    v_cvt_pk_bf16_f32 v138, v244, v245
    v_cvt_pk_bf16_f32 v139, v246, v247
    ds_write2_b64 v9, v[136:137], v[138:139] offset0:16 offset1:20
    s_waitcnt lgkmcnt(3)
    buffer_store_dwordx4 v[92:95], v7, s[32:35], s63 offen sc0 sc1
    v_pk_mul_f32 v[248:249], v[248:249], v[16:17] op_sel:[0,1]
    v_pk_mul_f32 v[250:251], v[250:251], v[16:17] op_sel:[0,1]
    v_cvt_pk_bf16_f32 v140, v248, v249
    v_cvt_pk_bf16_f32 v141, v250, v251
    v_pk_mul_f32 v[252:253], v[252:253], v[16:17] op_sel:[0,1]
    v_pk_mul_f32 v[254:255], v[254:255], v[16:17] op_sel:[0,1]
    v_cvt_pk_bf16_f32 v142, v252, v253
    v_cvt_pk_bf16_f32 v143, v254, v255
    ds_write2_b64 v9, v[140:141], v[142:143] offset0:24 offset1:28
    ds_read_b128 v[96:99], v11 offset:0
    ds_read_b128 v[100:103], v11 offset:1088
    ds_read_b128 v[104:107], v11 offset:2176
    ds_read_b128 v[108:111], v11 offset:3264
    s_waitcnt lgkmcnt(3)
    buffer_store_dwordx4 v[96:99], v8, s[32:35], s60 offen sc0 sc1
    s_waitcnt lgkmcnt(2)
    buffer_store_dwordx4 v[100:103], v8, s[32:35], s61 offen sc0 sc1
    s_waitcnt lgkmcnt(1)
    buffer_store_dwordx4 v[104:107], v8, s[32:35], s62 offen sc0 sc1
    s_waitcnt lgkmcnt(0)
    buffer_store_dwordx4 v[108:111], v8, s[32:35], s63 offen sc0 sc1
    s_branch L_snext
.p2align 6
L_table:
    .long 6885376, 7147520, 6885376, 8786432, 0, 16399, 0x1d1691, 0x0
    .long 6885376, 7147520, 6885376, 8786432, 512, 16399, 0x1d1691, 0x0
    .long 6885376, 7147520, 6885376, 8786432, 1024, 16399, 0x1d1691, 0x0
    .long 6885376, 7147520, 6885376, 8786432, 1536, 16399, 0x1d1691, 0x0
    .long 6885376, 7147520, 6885376, 8786432, 2048, 16399, 0x1d1691, 0x0
    .long 6885376, 7147520, 6885376, 8786432, 2560, 16399, 0x1d1691, 0x0
    .long 6885376, 7147520, 6885376, 8786432, 3072, 16399, 0x1d1691, 0x0
    .long 6885376, 7147520, 6885376, 8786432, 3584, 16399, 0x1d1691, 0x0
    .long 6885376, 7147520, 6885376, 8786432, 256, 16399, 0x1d1691, 0x0
    .long 6885376, 7147520, 6885376, 8786432, 768, 16399, 0x1d1691, 0x0
    .long 6885376, 7147520, 6885376, 8786432, 1280, 16399, 0x1d1691, 0x0
    .long 6885376, 7147520, 6885376, 8786432, 1792, 16399, 0x1d1691, 0x0
    .long 6885376, 7147520, 6885376, 8786432, 2304, 16399, 0x1d1691, 0x0
    .long 6885376, 7147520, 6885376, 8786432, 2816, 16399, 0x1d1691, 0x0
    .long 6885376, 7147520, 6885376, 8786432, 3328, 16399, 0x1d1691, 0x0
    .long 6885376, 7147520, 6885376, 8786432, 3840, 16399, 0x1d1691, 0x0
    .long 7409664, 7671808, 6885376, 8786432, 0, 18447, 0x3d1691, 0x0
    .long 7409664, 7671808, 6885376, 8786432, 512, 18447, 0x3d1691, 0x0
    .long 7409664, 7671808, 6885376, 8786432, 1024, 18447, 0x3d1691, 0x0
    .long 7409664, 7671808, 6885376, 8786432, 1536, 18447, 0x3d1691, 0x0
    .long 7409664, 7671808, 6885376, 8786432, 2048, 18447, 0x3d1691, 0x0
    .long 7409664, 7671808, 6885376, 8786432, 2560, 18447, 0x3d1691, 0x0
    .long 7409664, 7671808, 6885376, 8786432, 3072, 18447, 0x3d1691, 0x0
    .long 7409664, 7671808, 6885376, 8786432, 3584, 18447, 0x3d1691, 0x0
    .long 7409664, 7671808, 6885376, 8786432, 256, 18447, 0x3d1691, 0x0
    .long 7409664, 7671808, 6885376, 8786432, 768, 18447, 0x3d1691, 0x0
    .long 7409664, 7671808, 6885376, 8786432, 1280, 18447, 0x3d1691, 0x0
    .long 7409664, 7671808, 6885376, 8786432, 1792, 18447, 0x3d1691, 0x0
    .long 7409664, 7671808, 6885376, 8786432, 2304, 18447, 0x3d1691, 0x0
    .long 7409664, 7671808, 6885376, 8786432, 2816, 18447, 0x3d1691, 0x0
    .long 7409664, 7671808, 6885376, 8786432, 3328, 18447, 0x3d1691, 0x0
    .long 7409664, 7671808, 6885376, 8786432, 3840, 18447, 0x3d1691, 0x0
    .long 7933952, 8196096, 6885376, 8786432, 0, 16399, 0x5d1691, 0x0
    .long 7933952, 8196096, 6885376, 8786432, 512, 16399, 0x5d1691, 0x0
    .long 7933952, 8196096, 6885376, 8786432, 1024, 16399, 0x5d1691, 0x0
    .long 7933952, 8196096, 6885376, 8786432, 1536, 16399, 0x5d1691, 0x0
    .long 7933952, 8196096, 6885376, 8786432, 2048, 16399, 0x5d1691, 0x0
    .long 7933952, 8196096, 6885376, 8786432, 2560, 16399, 0x5d1691, 0x0
    .long 7933952, 8196096, 6885376, 8786432, 3072, 16399, 0x5d1691, 0x0
    .long 7933952, 8196096, 6885376, 8786432, 3584, 16399, 0x5d1691, 0x0
    .long 7933952, 8196096, 6885376, 8786432, 256, 16399, 0x5d1691, 0x0
    .long 7933952, 8196096, 6885376, 8786432, 768, 16399, 0x5d1691, 0x0
    .long 7933952, 8196096, 6885376, 8786432, 1280, 16399, 0x5d1691, 0x0
    .long 7933952, 8196096, 6885376, 8786432, 1792, 16399, 0x5d1691, 0x0
    .long 7933952, 8196096, 6885376, 8786432, 2304, 16399, 0x5d1691, 0x0
    .long 7933952, 8196096, 6885376, 8786432, 2816, 16399, 0x5d1691, 0x0
    .long 7933952, 8196096, 6885376, 8786432, 3328, 16399, 0x5d1691, 0x0
    .long 7933952, 8196096, 6885376, 8786432, 3840, 16399, 0x5d1691, 0x0
    .long 8458240, 8720384, 6885376, 8786432, 0, 18447, 0x7d1691, 0x0
    .long 8458240, 8720384, 6885376, 8786432, 512, 18447, 0x7d1691, 0x0
    .long 8458240, 8720384, 6885376, 8786432, 1024, 18447, 0x7d1691, 0x0
    .long 8458240, 8720384, 6885376, 8786432, 1536, 18447, 0x7d1691, 0x0
    .long 8458240, 8720384, 6885376, 8786432, 2048, 18447, 0x7d1691, 0x0
    .long 8458240, 8720384, 6885376, 8786432, 2560, 18447, 0x7d1691, 0x0
    .long 8458240, 8720384, 6885376, 8786432, 3072, 18447, 0x7d1691, 0x0
    .long 8458240, 8720384, 6885376, 8786432, 3584, 18447, 0x7d1691, 0x0
    .long 8458240, 8720384, 6885376, 8786432, 256, 18447, 0x7d1691, 0x0
    .long 8458240, 8720384, 6885376, 8786432, 768, 18447, 0x7d1691, 0x0
    .long 8458240, 8720384, 6885376, 8786432, 1280, 18447, 0x7d1691, 0x0
    .long 8458240, 8720384, 6885376, 8786432, 1792, 18447, 0x7d1691, 0x0
    .long 8458240, 8720384, 6885376, 8786432, 2304, 18447, 0x7d1691, 0x0
    .long 8458240, 8720384, 6885376, 8786432, 2816, 18447, 0x7d1691, 0x0
    .long 8458240, 8720384, 6885376, 8786432, 3328, 18447, 0x7d1691, 0x0
    .long 8458240, 8720384, 6885376, 8786432, 3840, 18447, 0x7d1691, 0x0
    .long 4030464, 4292608, 4030464, 4702720, 512, 518, 0xa53d8, 0x6462d
    .long 4030464, 4292608, 4030464, 4702720, 1024, 518, 0xa53d8, 0x6462d
    .long 4030464, 4292608, 4030464, 4702720, 1536, 518, 0xa53d8, 0x6462d
    .long 4030464, 4292608, 4030464, 4702720, 2048, 518, 0xa53d8, 0x6462d
    .long 4030464, 4292608, 4030464, 4702720, 2560, 518, 0xa53d8, 0x6462d
    .long 4030464, 4292608, 4030464, 4702720, 3072, 518, 0xa53d8, 0x6462d
    .long 4030464, 4292608, 4030464, 4702720, 3584, 518, 0xa53d8, 0x6462d
    .long 4030464, 4292608, 4030464, 4702720, 0, 518, 0xa53d8, 0x6462d
    .long 4030464, 4292608, 4030464, 4702720, 768, 518, 0xa53d8, 0x6462d
    .long 4030464, 4292608, 4030464, 4702720, 1280, 518, 0xa53d8, 0x6462d
    .long 4030464, 4292608, 4030464, 4702720, 1792, 518, 0xa53d8, 0x6462d
    .long 4030464, 4292608, 4030464, 4702720, 2304, 518, 0xa53d8, 0x6462d
    .long 4030464, 4292608, 4030464, 4702720, 2816, 518, 0xa53d8, 0x6462d
    .long 4030464, 4292608, 4030464, 4702720, 3328, 518, 0xa53d8, 0x6462d
    .long 4030464, 4292608, 4030464, 4702720, 3840, 518, 0xa53d8, 0x6462d
    .long 4030464, 4292608, 4030464, 4702720, 256, 518, 0xa53d8, 0x6462d
    .long 1957888, 2220032, 1957888, 2540032, 512, 2565, 0x8f1de, 0x6c172
    .long 1957888, 2220032, 1957888, 2540032, 1024, 2565, 0x8f1de, 0x6c172
    .long 1957888, 2220032, 1957888, 2540032, 1536, 2565, 0x8f1de, 0x6c172
    .long 1957888, 2220032, 1957888, 2540032, 2048, 2565, 0x8f1de, 0x6c172
    .long 1957888, 2220032, 1957888, 2540032, 2560, 2565, 0x8f1de, 0x6c172
    .long 1957888, 2220032, 1957888, 2540032, 3072, 2565, 0x8f1de, 0x6c172
    .long 1957888, 2220032, 1957888, 2540032, 3584, 2565, 0x8f1de, 0x6c172
    .long 1957888, 2220032, 1957888, 2540032, 0, 2565, 0x8f1de, 0x6c172
    .long 1957888, 2220032, 1957888, 2540032, 768, 2565, 0x8f1de, 0x6c172
    .long 1957888, 2220032, 1957888, 2540032, 1280, 2565, 0x8f1de, 0x6c172
    .long 1957888, 2220032, 1957888, 2540032, 1792, 2565, 0x8f1de, 0x6c172
    .long 1957888, 2220032, 1957888, 2540032, 2304, 2565, 0x8f1de, 0x6c172
    .long 1957888, 2220032, 1957888, 2540032, 2816, 2565, 0x8f1de, 0x6c172
    .long 1957888, 2220032, 1957888, 2540032, 3328, 2565, 0x8f1de, 0x6c172
    .long 1957888, 2220032, 1957888, 2540032, 3840, 2565, 0x8f1de, 0x6c172
    .long 1957888, 2220032, 1957888, 2540032, 256, 2565, 0x8f1de, 0x6c172
    .long 2482176, 2482432, 1957888, 2540032, 512, 261, 0x28f1de, 0x2a53d8
    .long 2482176, 2482432, 1957888, 2540032, 1024, 261, 0x28f1de, 0x2a53d8
    .long 2482176, 2482432, 1957888, 2540032, 1536, 261, 0x28f1de, 0x2a53d8
    .long 2482176, 2482432, 1957888, 2540032, 2048, 261, 0x28f1de, 0x2a53d8
    .long 2482176, 2482432, 1957888, 2540032, 2560, 261, 0x28f1de, 0x2a53d8
    .long 2482176, 2482432, 1957888, 2540032, 3072, 261, 0x28f1de, 0x2a53d8
    .long 2482176, 2482432, 1957888, 2540032, 3584, 261, 0x28f1de, 0x2a53d8
    .long 2482176, 2482432, 1957888, 2540032, 0, 261, 0x28f1de, 0x2a53d8
    .long 6279168, 6279424, 4706304, 6472192, 1024, 270, 0x7b047d, 0x0
    .long 6279168, 6279424, 4706304, 6472192, 1536, 270, 0x7b047d, 0x0
    .long 6279168, 6279424, 4706304, 6472192, 2048, 270, 0x7b047d, 0x0
    .long 6279168, 6279424, 4706304, 6472192, 2560, 270, 0x7b047d, 0x0
    .long 6279168, 6279424, 4706304, 6472192, 3072, 270, 0x7b047d, 0x0
    .long 6279168, 6279424, 4706304, 6472192, 3584, 270, 0x7b047d, 0x0
    .long 6279168, 6279424, 4706304, 6472192, 0, 270, 0x7b047d, 0x0
    .long 6279168, 6279424, 4706304, 6472192, 512, 270, 0x7b047d, 0x0
    .long 4706304, 4968448, 4706304, 6472192, 1024, 16910, 0x1b047d, 0x0
    .long 4706304, 4968448, 4706304, 6472192, 1536, 16910, 0x1b047d, 0x0
    .long 4706304, 4968448, 4706304, 6472192, 2048, 16910, 0x1b047d, 0x0
    .long 4706304, 4968448, 4706304, 6472192, 2560, 16910, 0x1b047d, 0x0
    .long 4706304, 4968448, 4706304, 6472192, 3072, 16910, 0x1b047d, 0x0
    .long 4706304, 4968448, 4706304, 6472192, 3584, 16910, 0x1b047d, 0x0
    .long 4706304, 4968448, 4706304, 6472192, 0, 16910, 0x1b047d, 0x0
    .long 4706304, 4968448, 4706304, 6472192, 512, 16910, 0x1b047d, 0x0
    .long 4706304, 4968448, 4706304, 6472192, 1280, 16910, 0x1b047d, 0x0
    .long 4706304, 4968448, 4706304, 6472192, 1792, 16910, 0x1b047d, 0x0
    .long 4706304, 4968448, 4706304, 6472192, 2304, 16910, 0x1b047d, 0x0
    .long 4706304, 4968448, 4706304, 6472192, 2816, 16910, 0x1b047d, 0x0
    .long 4706304, 4968448, 4706304, 6472192, 3328, 16910, 0x1b047d, 0x0
    .long 4706304, 4968448, 4706304, 6472192, 3840, 16910, 0x1b047d, 0x0
    .long 4706304, 4968448, 4706304, 6472192, 256, 16910, 0x1b047d, 0x0
    .long 4706304, 4968448, 4706304, 6472192, 768, 16910, 0x1b047d, 0x0
    .long 5230592, 5492736, 4706304, 6472192, 1024, 18958, 0x3b047d, 0x0
    .long 5230592, 5492736, 4706304, 6472192, 1536, 18958, 0x3b047d, 0x0
    .long 5230592, 5492736, 4706304, 6472192, 2048, 18958, 0x3b047d, 0x0
    .long 5230592, 5492736, 4706304, 6472192, 2560, 18958, 0x3b047d, 0x0
    .long 5230592, 5492736, 4706304, 6472192, 3072, 18958, 0x3b047d, 0x0
    .long 5230592, 5492736, 4706304, 6472192, 3584, 18958, 0x3b047d, 0x0
    .long 5230592, 5492736, 4706304, 6472192, 0, 18958, 0x3b047d, 0x0
    .long 5230592, 5492736, 4706304, 6472192, 512, 18958, 0x3b047d, 0x0
    .long 5230592, 5492736, 4706304, 6472192, 1280, 18958, 0x3b047d, 0x0
    .long 5230592, 5492736, 4706304, 6472192, 1792, 18958, 0x3b047d, 0x0
    .long 5230592, 5492736, 4706304, 6472192, 2304, 18958, 0x3b047d, 0x0
    .long 5230592, 5492736, 4706304, 6472192, 2816, 18958, 0x3b047d, 0x0
    .long 5230592, 5492736, 4706304, 6472192, 3328, 18958, 0x3b047d, 0x0
    .long 5230592, 5492736, 4706304, 6472192, 3840, 18958, 0x3b047d, 0x0
    .long 5230592, 5492736, 4706304, 6472192, 256, 18958, 0x3b047d, 0x0
    .long 5230592, 5492736, 4706304, 6472192, 768, 18958, 0x3b047d, 0x0
    .long 5754880, 6017024, 4706304, 6472192, 1024, 16910, 0x5b047d, 0x0
    .long 5754880, 6017024, 4706304, 6472192, 1536, 16910, 0x5b047d, 0x0
    .long 5754880, 6017024, 4706304, 6472192, 2048, 16910, 0x5b047d, 0x0
    .long 5754880, 6017024, 4706304, 6472192, 2560, 16910, 0x5b047d, 0x0
    .long 5754880, 6017024, 4706304, 6472192, 3072, 16910, 0x5b047d, 0x0
    .long 5754880, 6017024, 4706304, 6472192, 3584, 16910, 0x5b047d, 0x0
    .long 5754880, 6017024, 4706304, 6472192, 0, 16910, 0x5b047d, 0x0
    .long 5754880, 6017024, 4706304, 6472192, 512, 16910, 0x5b047d, 0x0
    .long 5754880, 6017024, 4706304, 6472192, 1280, 16910, 0x5b047d, 0x0
    .long 5754880, 6017024, 4706304, 6472192, 1792, 16910, 0x5b047d, 0x0
    .long 5754880, 6017024, 4706304, 6472192, 2304, 16910, 0x5b047d, 0x0
    .long 5754880, 6017024, 4706304, 6472192, 2816, 16910, 0x5b047d, 0x0
    .long 5754880, 6017024, 4706304, 6472192, 3328, 16910, 0x5b047d, 0x0
    .long 5754880, 6017024, 4706304, 6472192, 3840, 16910, 0x5b047d, 0x0
    .long 5754880, 6017024, 4706304, 6472192, 256, 16910, 0x5b047d, 0x0
    .long 5754880, 6017024, 4706304, 6472192, 768, 16910, 0x5b047d, 0x0
    .long 0, 262144, 0, 1511936, 2048, 49164, 0x172000, 0x0
    .long 0, 262144, 0, 1511936, 2560, 49164, 0x172000, 0x0
    .long 0, 262144, 0, 1511936, 3072, 49164, 0x172000, 0x0
    .long 0, 262144, 0, 1511936, 3584, 49164, 0x172000, 0x0
    .long 0, 262144, 0, 1511936, 0, 49164, 0x172000, 0x0
    .long 0, 262144, 0, 1511936, 512, 49164, 0x172000, 0x0
    .long 0, 262144, 0, 1511936, 1024, 49164, 0x172000, 0x0
    .long 0, 262144, 0, 1511936, 1536, 49164, 0x172000, 0x0
    .long 0, 262144, 0, 1511936, 2304, 49164, 0x172000, 0x0
    .long 0, 262144, 0, 1511936, 2816, 49164, 0x172000, 0x0
    .long 0, 262144, 0, 1511936, 3328, 49164, 0x172000, 0x0
    .long 0, 262144, 0, 1511936, 3840, 49164, 0x172000, 0x0
    .long 0, 262144, 0, 1511936, 256, 49164, 0x172000, 0x0
    .long 0, 262144, 0, 1511936, 768, 49164, 0x172000, 0x0
    .long 0, 262144, 0, 1511936, 1280, 49164, 0x172000, 0x0
    .long 0, 262144, 0, 1511936, 1792, 49164, 0x172000, 0x0
    .long 524288, 786432, 0, 1511936, 2048, 51212, 0x372000, 0x0
    .long 524288, 786432, 0, 1511936, 2560, 51212, 0x372000, 0x0
    .long 524288, 786432, 0, 1511936, 3072, 51212, 0x372000, 0x0
    .long 524288, 786432, 0, 1511936, 3584, 51212, 0x372000, 0x0
    .long 524288, 786432, 0, 1511936, 0, 51212, 0x372000, 0x0
    .long 524288, 786432, 0, 1511936, 512, 51212, 0x372000, 0x0
    .long 524288, 786432, 0, 1511936, 1024, 51212, 0x372000, 0x0
    .long 524288, 786432, 0, 1511936, 1536, 51212, 0x372000, 0x0
    .long 524288, 786432, 0, 1511936, 2304, 51212, 0x372000, 0x0
    .long 524288, 786432, 0, 1511936, 2816, 51212, 0x372000, 0x0
    .long 524288, 786432, 0, 1511936, 3328, 51212, 0x372000, 0x0
    .long 524288, 786432, 0, 1511936, 3840, 51212, 0x372000, 0x0
    .long 524288, 786432, 0, 1511936, 256, 51212, 0x372000, 0x0
    .long 524288, 786432, 0, 1511936, 768, 51212, 0x372000, 0x0
    .long 524288, 786432, 0, 1511936, 1280, 51212, 0x372000, 0x0
    .long 524288, 786432, 0, 1511936, 1792, 51212, 0x372000, 0x0
    .long 1048576, 1310720, 0, 1511936, 2048, 49164, 0x572000, 0x0
    .long 1048576, 1310720, 0, 1511936, 2560, 49164, 0x572000, 0x0
    .long 1048576, 1310720, 0, 1511936, 3072, 49164, 0x572000, 0x0
    .long 1048576, 1310720, 0, 1511936, 3584, 49164, 0x572000, 0x0
    .long 1048576, 1310720, 0, 1511936, 0, 49164, 0x572000, 0x0
    .long 1048576, 1310720, 0, 1511936, 512, 49164, 0x572000, 0x0
    .long 1048576, 1310720, 0, 1511936, 1024, 49164, 0x572000, 0x0
    .long 1048576, 1310720, 0, 1511936, 1536, 49164, 0x572000, 0x0
    .long 1048576, 1310720, 0, 1511936, 2304, 49164, 0x572000, 0x0
    .long 1048576, 1310720, 0, 1511936, 2816, 49164, 0x572000, 0x0
    .long 1048576, 1310720, 0, 1511936, 3328, 49164, 0x572000, 0x0
    .long 1048576, 1310720, 0, 1511936, 3840, 49164, 0x572000, 0x0
    .long 1048576, 1310720, 0, 1511936, 256, 49164, 0x572000, 0x0
    .long 1048576, 1310720, 0, 1511936, 768, 49164, 0x572000, 0x0
    .long 1048576, 1310720, 0, 1511936, 1280, 49164, 0x572000, 0x0
    .long 1048576, 1310720, 0, 1511936, 1792, 49164, 0x572000, 0x0
    .long 2543616, 2805760, 2543616, 4026880, 3072, 49164, 0x16b26d, 0x0
    .long 2543616, 2805760, 2543616, 4026880, 3584, 49164, 0x16b26d, 0x0
    .long 2543616, 2805760, 2543616, 4026880, 0, 49164, 0x16b26d, 0x0
    .long 2543616, 2805760, 2543616, 4026880, 512, 49164, 0x16b26d, 0x0
    .long 2543616, 2805760, 2543616, 4026880, 1024, 49164, 0x16b26d, 0x0
    .long 2543616, 2805760, 2543616, 4026880, 1536, 49164, 0x16b26d, 0x0
    .long 2543616, 2805760, 2543616, 4026880, 2048, 49164, 0x16b26d, 0x0
    .long 2543616, 2805760, 2543616, 4026880, 2560, 49164, 0x16b26d, 0x0
    .long 2543616, 2805760, 2543616, 4026880, 3328, 49164, 0x16b26d, 0x0
    .long 2543616, 2805760, 2543616, 4026880, 3840, 49164, 0x16b26d, 0x0
    .long 2543616, 2805760, 2543616, 4026880, 256, 49164, 0x16b26d, 0x0
    .long 2543616, 2805760, 2543616, 4026880, 768, 49164, 0x16b26d, 0x0
    .long 2543616, 2805760, 2543616, 4026880, 1280, 49164, 0x16b26d, 0x0
    .long 2543616, 2805760, 2543616, 4026880, 1792, 49164, 0x16b26d, 0x0
    .long 2543616, 2805760, 2543616, 4026880, 2304, 49164, 0x16b26d, 0x0
    .long 2543616, 2805760, 2543616, 4026880, 2816, 49164, 0x16b26d, 0x0
    .long 3067904, 3330048, 2543616, 4026880, 3072, 51212, 0x36b26d, 0x0
    .long 3067904, 3330048, 2543616, 4026880, 3584, 51212, 0x36b26d, 0x0
    .long 3067904, 3330048, 2543616, 4026880, 0, 51212, 0x36b26d, 0x0
    .long 3067904, 3330048, 2543616, 4026880, 512, 51212, 0x36b26d, 0x0
    .long 3067904, 3330048, 2543616, 4026880, 1024, 51212, 0x36b26d, 0x0
    .long 3067904, 3330048, 2543616, 4026880, 1536, 51212, 0x36b26d, 0x0
    .long 3067904, 3330048, 2543616, 4026880, 2048, 51212, 0x36b26d, 0x0
    .long 3067904, 3330048, 2543616, 4026880, 2560, 51212, 0x36b26d, 0x0
    .long 3067904, 3330048, 2543616, 4026880, 3328, 51212, 0x36b26d, 0x0
    .long 3067904, 3330048, 2543616, 4026880, 3840, 51212, 0x36b26d, 0x0
    .long 3067904, 3330048, 2543616, 4026880, 256, 51212, 0x36b26d, 0x0
    .long 3067904, 3330048, 2543616, 4026880, 768, 51212, 0x36b26d, 0x0
    .long 3067904, 3330048, 2543616, 4026880, 1280, 51212, 0x36b26d, 0x0
    .long 3067904, 3330048, 2543616, 4026880, 1792, 51212, 0x36b26d, 0x0
    .long 3067904, 3330048, 2543616, 4026880, 2304, 51212, 0x36b26d, 0x0
    .long 3067904, 3330048, 2543616, 4026880, 2816, 51212, 0x36b26d, 0x0
    .long 3592192, 3854336, 2543616, 4026880, 3072, 49164, 0x56b26d, 0x0
    .long 3592192, 3854336, 2543616, 4026880, 3584, 49164, 0x56b26d, 0x0
    .long 3592192, 3854336, 2543616, 4026880, 0, 49164, 0x56b26d, 0x0
    .long 3592192, 3854336, 2543616, 4026880, 512, 49164, 0x56b26d, 0x0
    .long 3592192, 3854336, 2543616, 4026880, 1024, 49164, 0x56b26d, 0x0
    .long 3592192, 3854336, 2543616, 4026880, 1536, 49164, 0x56b26d, 0x0
    .long 3592192, 3854336, 2543616, 4026880, 2048, 49164, 0x56b26d, 0x0
    .long 3592192, 3854336, 2543616, 4026880, 2560, 49164, 0x56b26d, 0x0
    .long 3592192, 3854336, 2543616, 4026880, 3328, 49164, 0x56b26d, 0x0
    .long 3592192, 3854336, 2543616, 4026880, 3840, 49164, 0x56b26d, 0x0
    .long 3592192, 3854336, 2543616, 4026880, 256, 49164, 0x56b26d, 0x0
    .long 3592192, 3854336, 2543616, 4026880, 768, 49164, 0x56b26d, 0x0
    .long 3592192, 3854336, 2543616, 4026880, 1280, 49164, 0x56b26d, 0x0
    .long 3592192, 3854336, 2543616, 4026880, 1792, 49164, 0x56b26d, 0x0
    .long 3592192, 3854336, 2543616, 4026880, 2304, 49164, 0x56b26d, 0x0
    .long 3592192, 3854336, 2543616, 4026880, 2816, 49164, 0x56b26d, 0x0
    .fill 256, 4, 0
.section .rodata,"a"
.p2align 6
.amdhsa_kernel standalone__ragged_sequences_packed_sequences__ragged_kernel
  .amdhsa_next_free_vgpr 256
  .amdhsa_next_free_sgpr 102
  .amdhsa_accum_offset 256
  .amdhsa_group_segment_fixed_size 0
  .amdhsa_kernarg_size 56
  .amdhsa_user_sgpr_count 2
  .amdhsa_user_sgpr_kernarg_segment_ptr 1
  .amdhsa_system_sgpr_workgroup_id_x 1
.end_amdhsa_kernel
```
